```python
import torch

def _softmax(x, axis=-1):
    return torch.softmax(x, dim=axis)
def _gelu(x):
    return torch.nn.functional.gelu(x, approximate="tanh")
def _silu(x):
    return torch.nn.functional.silu(x)
def _sigmoid(x):
    return torch.sigmoid(x)
def _layernorm(x, axis=-1, eps=1e-5):
    m = x.mean(dim=axis, keepdim=True)
    v = x.var(dim=axis, keepdim=True, unbiased=False)
    return (x - m) / torch.sqrt(v + eps)
def _scatter_add(tgt, idx, src, axis=0):
    return tgt.clone().index_add_(axis, idx, src)
def _segment_sum(src, seg, n):
    out = torch.zeros((n,) + src.shape[1:], dtype=src.dtype)
    return out.index_add_(0, seg, src)
def _pad(x, pw):
    flat = tuple(v for pair in reversed(pw) for v in pair)
    return torch.nn.functional.pad(x, flat)

kernel_name = 'standalone__edge_featured_mpnn_gatedgcn__graph'

def setup_inputs():

    _w = (lambda a: (lambda t: t.to(torch.bfloat16) if t.is_floating_point() else t)(torch.as_tensor(a)))
    N, deg, D, De = 12500, 64, 64, max(16, 1)
    E = N * deg
    return {
        "x": _w((lambda *s: torch.randn(*s, dtype=torch.bfloat16) * 0.8)(N, D)),
        "e_attr": _w((lambda *s: torch.randn(*s, dtype=torch.bfloat16) * 0.8)(E, De)),
        "src": _w((lambda lo, hi, *s: torch.randint(lo, hi, s))(0, N, E).to(torch.int64)),
        "dst": _w((lambda lo, hi, *s: torch.randint(lo, hi, s))(0, N, E).to(torch.int64)),
        "w_a": _w((lambda *s: torch.randn(*s, dtype=torch.bfloat16) * 0.8)(D, D)),
        "w_b": _w((lambda *s: torch.randn(*s, dtype=torch.bfloat16) * 0.8)(D, D)),
        "w_c": _w((lambda *s: torch.randn(*s, dtype=torch.bfloat16) * 0.8)(De, D)),
        "w_u": _w((lambda *s: torch.randn(*s, dtype=torch.bfloat16) * 0.05)(D, D)),
        "w_v": _w((lambda *s: torch.randn(*s, dtype=torch.bfloat16) * 0.05)(D, D)),
    }

def reference(x, e_attr, src, dst, w_a, w_b, w_c, w_u, w_v):
    N, D = x.shape
    hv = x @ w_v
    g = x[dst] @ w_a + x[src] @ w_b + e_attr @ w_c
    eta = _sigmoid(g)
    denom = _segment_sum(eta, dst, N) + 1e-6
    eta_n = eta / denom[dst]
    agg = _segment_sum(eta_n * hv[src], dst, N)
    z = x @ w_u + agg
    relu_z = torch.where(z > 0, z, 0 * z)
    return x + relu_z
```

```asm
; @launch kernel=bucket_kernel grid=(256,1,1) block=(1024,1,1) lds=36864
; @launch kernel=standalone__edge_featured_mpnn_gatedgcn__graph_kernel grid=(256,1,1) block=(512,1,1) lds=162560
.amdgcn_target "amdgcn-amd-amdhsa--gfx950"
.text
.globl bucket_kernel
.p2align 8
.type bucket_kernel,@function
bucket_kernel:
    s_cmp_gt_u32 s2, 255
    s_cbranch_scc1 K1_END
    s_load_dwordx4 s[4:7], s[0:1], 16
    s_load_dwordx2 s[8:9], s[0:1], 88
    v_lshlrev_b32 v1, 4, v0
    v_mov_b32 v4, 0
    v_mov_b32 v5, 0
    v_mov_b32 v6, 0
    v_mov_b32 v7, 0
    v_lshlrev_b32 v2, 2, v0
    ds_write_b128 v1, v[4:7]
    ds_write_b128 v1, v[4:7] offset:16384

    ds_write_b32 v2, v4 offset:32768
    s_mul_i32 s10, s2, 12500
    s_sub_u32 s11, 3200000, s10
    s_min_u32 s11, s11, 12500
    s_waitcnt lgkmcnt(0)
    s_add_u32 s12, s6, s10
    s_addc_u32 s13, s7, 0
    s_and_b32 s13, s13, 0xffff
    s_mov_b32 s14, s11
    s_mov_b32 s15, 0x20000
    s_add_u32 s16, s4, s10
    s_addc_u32 s17, s5, 0
    s_and_b32 s17, s17, 0xffff
    s_mov_b32 s18, s11
    s_mov_b32 s19, 0x20000
    buffer_load_dwordx4 v[8:11], v1, s[12:15], 0 offen
    buffer_load_dwordx4 v[12:15], v1, s[16:19], 0 offen

    s_mov_b32 s20, s8
    s_and_b32 s21, s9, 0xffff
    s_mov_b32 s22, 11588608
    s_mov_b32 s23, 0x20000
    s_barrier
    v_lshrrev_b32 v60, 6, v0
    s_nop 0
    v_readfirstlane_b32 s43, v60
    s_nop 3
    s_cmp_eq_u32 s43, 13
    s_cselect_b32 s44, s2, 64
    s_cmp_lt_u32 s44, 34
    s_cbranch_scc1 K1_WEIGHTS
    v_lshlrev_b32 v3, 2, v0
    v_add_u32 v16, 0, v3
    v_add_u32 v17, 1, v3
    v_add_u32 v18, 2, v3
    v_add_u32 v19, 3, v3
    s_lshr_b32 s11, s11, 2
    v_cmp_gt_u32 s[24:25], s11, v16
    v_cmp_gt_u32 s[26:27], s11, v17
    v_cmp_gt_u32 s[28:29], s11, v18
    v_cmp_gt_u32 s[30:31], s11, v19
    v_mov_b32 v40, 1
    s_movk_i32 s10, 21400
    s_waitcnt vmcnt(1)
    v_mul_u32_u24 v20, s10, v8
    v_mul_u32_u24 v21, s10, v9
    v_mul_u32_u24 v22, s10, v10
    v_mul_u32_u24 v23, s10, v11
    v_lshrrev_b32 v20, 20, v20
    v_lshrrev_b32 v21, 20, v21
    v_lshrrev_b32 v22, 20, v22
    v_lshrrev_b32 v23, 20, v23
    v_mul_u32_u24 v24, 49, v20
    v_lshlrev_b32 v28, 2, v20
    v_mul_u32_u24 v25, 49, v21
    v_lshlrev_b32 v29, 2, v21
    v_mul_u32_u24 v26, 49, v22
    v_lshlrev_b32 v30, 2, v22
    v_mul_u32_u24 v27, 49, v23
    v_lshlrev_b32 v31, 2, v23
    s_mov_b64 exec, s[24:25]
    ds_add_rtn_u32 v32, v28, v40 offset:32768
    s_mov_b64 exec, s[26:27]
    ds_add_rtn_u32 v33, v29, v40 offset:32768
    s_mov_b64 exec, s[28:29]
    ds_add_rtn_u32 v34, v30, v40 offset:32768
    s_mov_b64 exec, s[30:31]
    ds_add_rtn_u32 v35, v31, v40 offset:32768
    s_mov_b64 exec, -1
    v_sub_u32 v24, v8, v24
    v_lshl_add_u32 v16, v16, 6, v24
    v_sub_u32 v25, v9, v25
    v_lshl_add_u32 v17, v17, 6, v25
    v_sub_u32 v26, v10, v26
    v_lshl_add_u32 v18, v18, 6, v26
    v_sub_u32 v27, v11, v27
    v_lshl_add_u32 v19, v19, 6, v27
    s_waitcnt vmcnt(0)
    v_lshl_add_u32 v16, v12, 18, v16
    v_add_u32 v16, 1, v16
    v_lshlrev_b32 v24, 7, v20
    v_lshl_add_u32 v17, v13, 18, v17
    v_add_u32 v17, 1, v17
    v_lshlrev_b32 v25, 7, v21
    v_lshl_add_u32 v18, v14, 18, v18
    v_add_u32 v18, 1, v18
    v_lshlrev_b32 v26, 7, v22
    v_lshl_add_u32 v19, v15, 18, v19
    v_add_u32 v19, 1, v19
    v_lshlrev_b32 v27, 7, v23
    s_waitcnt lgkmcnt(0)
    v_cmp_lt_u32 vcc, 14, v32
    s_nop 1
    v_addc_co_u32 v36, vcc, 0, v32, vcc
    v_lshl_add_u32 v24, v36, 2, v24
    v_cmp_lt_u32 vcc, 14, v33
    s_nop 1
    v_addc_co_u32 v36, vcc, 0, v33, vcc
    v_lshl_add_u32 v25, v36, 2, v25
    v_cmp_lt_u32 vcc, 14, v34
    s_nop 1
    v_addc_co_u32 v36, vcc, 0, v34, vcc
    v_lshl_add_u32 v26, v36, 2, v26
    v_cmp_lt_u32 vcc, 14, v35
    s_nop 1
    v_addc_co_u32 v36, vcc, 0, v35, vcc
    v_lshl_add_u32 v27, v36, 2, v27
    s_mov_b64 s[34:35], 0
    v_cmp_gt_u32 vcc, 31, v32
    s_and_b64 exec, vcc, s[24:25]
    ds_write_b32 v24, v16
    s_andn2_b64 s[36:37], s[24:25], vcc
    s_or_b64 s[34:35], s[34:35], s[36:37]
    s_mov_b64 exec, -1
    v_cmp_gt_u32 vcc, 31, v33
    s_and_b64 exec, vcc, s[26:27]
    ds_write_b32 v25, v17
    s_andn2_b64 s[36:37], s[26:27], vcc
    s_or_b64 s[34:35], s[34:35], s[36:37]
    s_mov_b64 exec, -1
    v_cmp_gt_u32 vcc, 31, v34
    s_and_b64 exec, vcc, s[28:29]
    ds_write_b32 v26, v18
    s_andn2_b64 s[36:37], s[28:29], vcc
    s_or_b64 s[34:35], s[34:35], s[36:37]
    s_mov_b64 exec, -1
    v_cmp_gt_u32 vcc, 31, v35
    s_and_b64 exec, vcc, s[30:31]
    ds_write_b32 v27, v19
    s_andn2_b64 s[36:37], s[30:31], vcc
    s_or_b64 s[34:35], s[34:35], s[36:37]
    s_mov_b64 exec, -1
    s_cmp_eq_u64 s[34:35], 0
    s_cbranch_scc1 K1_NOFLAG
    v_mov_b32 v41, 33792
    ds_write_b32 v41, v40
K1_NOFLAG:
    s_waitcnt lgkmcnt(0)
    s_barrier
    v_mov_b32 v41, 33792
    ds_read_b32 v42, v41
    v_lshrrev_b32 v52, 2, v0
    v_and_b32 v53, 3, v0
    v_lshlrev_b32 v56, 7, v52
    v_lshl_add_u32 v56, v53, 4, v56
    v_lshlrev_b32 v57, 2, v52

    ds_read_b128 v[44:47], v56
    ds_read_b128 v[48:51], v56 offset:64
    ds_read_b32 v43, v57 offset:32768
    v_add_u32 v54, s2, v52
    v_and_b32 v54, 255, v54
    v_lshlrev_b32 v54, 6, v54
    v_lshl_add_u32 v54, v53, 4, v54
    v_lshl_add_u32 v54, v52, 14, v54
    v_add_u32 v55, 0x400000, v54
    v_cmp_eq_u32 s[40:41], 3, v53

    s_waitcnt lgkmcnt(3)
    v_readfirstlane_b32 s10, v42
    s_nop 3
    s_cmp_lg_u32 s10, 0
    s_cbranch_scc1 K1_SLOW
K1_COPY:
    s_waitcnt lgkmcnt(0)
    v_cmp_lt_u32 vcc, 15, v43
    s_and_b64 s[42:43], vcc, s[40:41]
    v_mov_b32 v58, 62
    s_nop 0
    v_cndmask_b32 v47, v47, v58, s[42:43]
    buffer_store_dwordx4 v[44:47], v54, s[20:23], 0 offen sc1
    s_and_saveexec_b64 s[42:43], vcc
    s_cbranch_execz K1_NOHI
    buffer_store_dwordx4 v[48:51], v55, s[20:23], 0 offen sc1
K1_NOHI:
    s_mov_b64 exec, s[42:43]
    s_endpgm
K1_SLOW:
    s_waitcnt lgkmcnt(0)
    v_cmp_gt_u32 vcc, 0x100, v0
    s_and_saveexec_b64 s[38:39], vcc
    s_cbranch_execz K1_S1
    ds_read_b32 v57, v2 offset:32768
    s_waitcnt lgkmcnt(0)
    v_cmp_lt_u32 vcc, 31, v57
    s_and_b64 exec, exec, vcc
    s_cbranch_execz K1_S1
    v_subrev_u32 v57, 30, v57
    v_mov_b32 v58, 33796
    ds_add_rtn_u32 v56, v58, v57
    v_lshlrev_b32 v58, 7, v0
    s_waitcnt lgkmcnt(0)
    ds_write_b32 v2, v56 offset:34816
    v_lshlrev_b32 v59, 6, v56
    v_lshl_add_u32 v59, v57, 18, v59
    v_or_b32 v59, 63, v59
    ds_write_b32 v58, v59 offset:124
K1_S1:
    s_mov_b64 exec, -1
    s_waitcnt lgkmcnt(0)
    s_barrier
    s_mul_i32 s10, s2, 12500
    s_add_u32 s10, s10, 8388608
    v_cmp_lt_u32 vcc, 29, v32
    s_and_b64 exec, vcc, s[24:25]
    s_cbranch_execz K1_SK_1
    ds_read_b32 v57, v28 offset:32768
    ds_read_b32 v58, v28 offset:34816
    s_waitcnt lgkmcnt(0)
    v_cmp_lt_u32 vcc, 31, v57
    s_and_b64 exec, exec, vcc
    s_cbranch_execz K1_SK_1
    v_add_u32 v58, v58, v32
    v_subrev_u32 v58, 30, v58
    v_lshlrev_b32 v58, 2, v58
    buffer_store_dword v16, v58, s[20:23], s10 offen
K1_SK_1:
    s_mov_b64 exec, -1
    v_cmp_lt_u32 vcc, 29, v33
    s_and_b64 exec, vcc, s[26:27]
    s_cbranch_execz K1_SK_2
    ds_read_b32 v57, v29 offset:32768
    ds_read_b32 v58, v29 offset:34816
    s_waitcnt lgkmcnt(0)
    v_cmp_lt_u32 vcc, 31, v57
    s_and_b64 exec, exec, vcc
    s_cbranch_execz K1_SK_2
    v_add_u32 v58, v58, v33
    v_subrev_u32 v58, 30, v58
    v_lshlrev_b32 v58, 2, v58
    buffer_store_dword v17, v58, s[20:23], s10 offen
K1_SK_2:
    s_mov_b64 exec, -1
    v_cmp_lt_u32 vcc, 29, v34
    s_and_b64 exec, vcc, s[28:29]
    s_cbranch_execz K1_SK_3
    ds_read_b32 v57, v30 offset:32768
    ds_read_b32 v58, v30 offset:34816
    s_waitcnt lgkmcnt(0)
    v_cmp_lt_u32 vcc, 31, v57
    s_and_b64 exec, exec, vcc
    s_cbranch_execz K1_SK_3
    v_add_u32 v58, v58, v34
    v_subrev_u32 v58, 30, v58
    v_lshlrev_b32 v58, 2, v58
    buffer_store_dword v18, v58, s[20:23], s10 offen
K1_SK_3:
    s_mov_b64 exec, -1
    v_cmp_lt_u32 vcc, 29, v35
    s_and_b64 exec, vcc, s[30:31]
    s_cbranch_execz K1_SK_4
    ds_read_b32 v57, v31 offset:32768
    ds_read_b32 v58, v31 offset:34816
    s_waitcnt lgkmcnt(0)
    v_cmp_lt_u32 vcc, 31, v57
    s_and_b64 exec, exec, vcc
    s_cbranch_execz K1_SK_4
    v_add_u32 v58, v58, v35
    v_subrev_u32 v58, 30, v58
    v_lshlrev_b32 v58, 2, v58
    buffer_store_dword v19, v58, s[20:23], s10 offen
K1_SK_4:
    s_mov_b64 exec, -1
    v_lshrrev_b32 v52, 2, v0
    v_and_b32 v53, 3, v0
    v_lshlrev_b32 v56, 7, v52
    v_lshl_add_u32 v56, v53, 4, v56
    ds_read_b128 v[48:51], v56 offset:64
    s_branch K1_COPY
K1_WEIGHTS:
    s_load_dwordx8 s[12:19], s[0:1], 32
    s_load_dwordx2 s[46:47], s[0:1], 64
    v_and_b32 v2, 63, v0
    v_and_b32 v3, 31, v2
    v_lshrrev_b32 v62, 5, v2

    s_mov_b32 s45, s2
    s_waitcnt lgkmcnt(0)
    s_mov_b32 s40, s8
    s_and_b32 s41, s9, 0xffff
    s_mov_b32 s42, 12617728
    s_mov_b32 s43, 0x20000
    s_cmp_ge_u32 s45, 8
    s_cbranch_scc1 K1_WN_6
    s_mov_b32 s24, s14
    s_and_b32 s25, s15, 0xffff
    s_mov_b32 s26, 8192
    s_mov_b32 s27, 0x20000
    s_sub_u32 s33, s45, 0
    s_mov_b32 s34, 4096
    s_branch K1_WSEL_5
K1_WN_6:
    s_cmp_ge_u32 s45, 16
    s_cbranch_scc1 K1_WN_7
    s_mov_b32 s24, s46
    s_and_b32 s25, s47, 0xffff
    s_mov_b32 s26, 8192
    s_mov_b32 s27, 0x20000
    s_sub_u32 s33, s45, 8
    s_mov_b32 s34, 4096
    s_branch K1_WSEL_5
K1_WN_7:
    s_cmp_ge_u32 s45, 18
    s_cbranch_scc1 K1_WN_8
    s_mov_b32 s24, s16
    s_and_b32 s25, s17, 0xffff
    s_mov_b32 s26, 2048
    s_mov_b32 s27, 0x20000
    s_sub_u32 s33, s45, 16
    s_mov_b32 s34, 1024
    s_branch K1_WSEL_5
K1_WN_8:
    s_cmp_ge_u32 s45, 26
    s_cbranch_scc1 K1_WN_9
    s_mov_b32 s24, s12
    s_and_b32 s25, s13, 0xffff
    s_mov_b32 s26, 8192
    s_mov_b32 s27, 0x20000
    s_sub_u32 s33, s45, 18
    s_mov_b32 s34, 4096
    s_branch K1_WSEL_5
K1_WN_9:
    s_mov_b32 s24, s18
    s_and_b32 s25, s19, 0xffff
    s_mov_b32 s26, 8192
    s_mov_b32 s27, 0x20000
    s_sub_u32 s33, s45, 26
    s_mov_b32 s34, 4096
K1_WSEL_5:
    s_lshr_b32 s35, s33, 1
    s_and_b32 s36, s33, 1
    s_lshl_b32 s35, s35, 10
    s_lshl_b32 s36, s36, 6
    s_add_u32 s35, s35, s36
    v_mul_lo_u32 v5, v62, s34
    v_lshl_add_u32 v5, v3, 1, v5

    s_waitcnt vmcnt(0)
    buffer_load_ushort v8, v5, s[24:27], s35 offen offset:0
    buffer_load_ushort v9, v5, s[24:27], s35 offen offset:128
    buffer_load_ushort v10, v5, s[24:27], s35 offen offset:256
    buffer_load_ushort v11, v5, s[24:27], s35 offen offset:384
    buffer_load_ushort v12, v5, s[24:27], s35 offen offset:512
    buffer_load_ushort v13, v5, s[24:27], s35 offen offset:640
    buffer_load_ushort v14, v5, s[24:27], s35 offen offset:768
    buffer_load_ushort v15, v5, s[24:27], s35 offen offset:896
    s_lshl_b32 s37, s45, 10
    s_add_u32 s37, s37, 12582912
    v_lshlrev_b32 v6, 4, v2
    s_waitcnt vmcnt(0)
    s_cmp_lt_u32 s45, 8
    s_cbranch_scc1 K1_WSC_11
    s_sub_u32 s38, s45, 16
    s_cmp_lt_u32 s38, 2
    s_cbranch_scc1 K1_WSC_11
    v_lshl_or_b32 v16, v9, 16, v8
    v_lshl_or_b32 v17, v11, 16, v10
    v_lshl_or_b32 v18, v13, 16, v12
    v_lshl_or_b32 v19, v15, 16, v14
    s_branch K1_WDN_12
K1_WSC_11:
    s_mov_b32 s38, 0xbfb8aa3b
    v_lshlrev_b32 v8, 16, v8
    v_mul_f32 v8, s38, v8
    v_lshlrev_b32 v9, 16, v9
    v_mul_f32 v9, s38, v9
    v_lshlrev_b32 v10, 16, v10
    v_mul_f32 v10, s38, v10
    v_lshlrev_b32 v11, 16, v11
    v_mul_f32 v11, s38, v11
    v_lshlrev_b32 v12, 16, v12
    v_mul_f32 v12, s38, v12
    v_lshlrev_b32 v13, 16, v13
    v_mul_f32 v13, s38, v13
    v_lshlrev_b32 v14, 16, v14
    v_mul_f32 v14, s38, v14
    v_lshlrev_b32 v15, 16, v15
    v_mul_f32 v15, s38, v15
    v_cvt_pk_bf16_f32 v16, v8, v9
    v_cvt_pk_bf16_f32 v17, v10, v11
    v_cvt_pk_bf16_f32 v18, v12, v13
    v_cvt_pk_bf16_f32 v19, v14, v15
K1_WDN_12:
    buffer_store_dwordx4 v[16:19], v6, s[40:43], s37 offen sc1
    s_mov_b64 s[24:25], 0
    s_mov_b64 s[26:27], 0
    s_mov_b64 s[28:29], 0
    s_mov_b64 s[30:31], 0
    v_lshlrev_b32 v2, 2, v0
    v_mov_b32 v4, 0
    v_mov_b32 v5, 0
    v_mov_b32 v6, 0
    v_mov_b32 v7, 0
    s_branch K1_NOFLAG
K1_END:
    s_endpgm
.globl standalone__edge_featured_mpnn_gatedgcn__graph_kernel
.p2align 8
.type standalone__edge_featured_mpnn_gatedgcn__graph_kernel,@function
standalone__edge_featured_mpnn_gatedgcn__graph_kernel:
    s_cmp_ge_u32 s2, 256
    s_cbranch_scc1 K3_END
    s_load_dwordx2 s[10:11], s[0:1], 88
    s_load_dwordx4 s[4:7], s[0:1], 0
    s_load_dwordx2 s[8:9], s[0:1], 72
    v_lshrrev_b32 v1, 6, v0
    v_and_b32 v13, 63, v0
    v_readfirstlane_b32 s28, v1
    s_mul_i32 s29, s2, 49
    s_movk_i32 s35, 128
    s_mov_b32 s32, 0
    s_mov_b32 s47, 0
    s_mov_b32 s30, 200000
    v_lshrrev_b32 v8, 3, v0
    v_and_b32 v9, 7, v0
    v_lshlrev_b32 v9, 3, v9
    s_lshl_b32 s37, s2, 14
    v_add_u32 v9, s37, v9
    v_add_u32 v10, s2, v8

    v_add_u32 v11, 0, v10
    v_and_b32 v11, 255, v11
    v_lshl_add_u32 v164, v11, 6, v9
    v_add_u32 v11, 64, v10
    v_and_b32 v11, 255, v11
    v_lshl_add_u32 v165, v11, 6, v9
    v_add_u32 v11, 128, v10
    v_and_b32 v11, 255, v11
    v_lshl_add_u32 v166, v11, 6, v9
    v_add_u32 v11, 192, v10
    v_and_b32 v11, 255, v11
    v_lshl_add_u32 v167, v11, 6, v9
    s_movk_i32 s37, 3125
    v_mul_u32_u24 v3, s37, v8
    v_lshrrev_b32 v10, 3, v13
    v_and_b32 v11, 7, v13
    v_lshrrev_b32 v12, 1, v10
    v_xor_b32 v11, v11, v12
    v_lshlrev_b32 v11, 4, v11

    v_add_u32 v140, 3072, v11
    v_xor_b32 v12, 64, v11
    v_add_u32 v141, 2048, v12
    v_add_u32 v142, 1024, v11
    v_xor_b32 v12, 64, v11
    v_add_u32 v143, 0, v12
    s_and_b32 s37, s28, 1
    s_lshl_b32 s37, s37, 6
    v_xor_b32 v11, s37, v11
    s_lshl_b32 s38, s28, 3
    s_add_u32 s38, s38, s29
    v_add_u32 v10, s38, v10
    v_lshl_add_u32 v10, v10, 7, v11
    v_add_u32 v128, 3072, v10
    v_lshlrev_b32 v129, 4, v13
    v_lshrrev_b32 v8, 3, v0
    v_add_u32 v8, s29, v8
    v_lshlrev_b32 v8, 7, v8
    v_and_b32 v9, 7, v0
    v_lshl_add_u32 v8, v9, 4, v8
    v_add_u32 v130, 3072, v8
    s_lshl_b32 s80, s28, 12
    s_add_u32 s33, s80, 97024
    s_add_u32 s34, s33, 32768
    v_mov_b32 v4, 0
    v_mov_b32 v5, 0
    v_mov_b32 v6, 0
    v_mov_b32 v7, 0
    v_lshlrev_b32 v8, 4, v0
    v_add_u32 v9, 97024, v8
    v_cmp_gt_u32 vcc, 176, v0
    s_and_saveexec_b64 s[38:39], vcc
    ds_write_b128 v9, v[4:7]
    s_mov_b64 exec, s[38:39]
    v_mov_b32 v9, 4
    v_mov_b32 v8, 16
    ds_write_b32 v9, v8
    s_waitcnt lgkmcnt(0)
    s_mov_b32 s40, s10
    s_and_b32 s41, s11, 0xffff
    s_mov_b32 s42, 8388608
    s_mov_b32 s43, 0x20000
    buffer_load_dwordx2 v[16:17], v164, s[40:43], 0 offen
    buffer_load_dwordx2 v[18:19], v165, s[40:43], 0 offen
    buffer_load_dwordx2 v[20:21], v166, s[40:43], 0 offen
    buffer_load_dwordx2 v[22:23], v167, s[40:43], 0 offen
    s_barrier
    s_sub_u32 s12, s4, 3072
    s_subb_u32 s13, s5, 0
    s_and_b32 s13, s13, 0xffff
    s_mov_b32 s14, 1603072
    s_mov_b32 s15, 0x20000
    s_mov_b32 s20, s10
    s_and_b32 s21, s11, 0xffff
    s_mov_b32 s22, 12617728
    s_mov_b32 s23, 0x20000
    s_mov_b32 s16, s6
    s_and_b32 s17, s7, 0xffff
    s_mov_b32 s18, 25600000
    s_mov_b32 s19, 0x20000
    s_mov_b32 s24, s8
    s_and_b32 s25, s9, 0xffff
    s_mov_b32 s26, 1600000
    s_mov_b32 s27, 0x20000
    v_mov_b32 v4, 0
    v_mov_b32 v8, 0
    ds_write_b32 v8, v4
    v_and_b32 v8, 31, v13
    v_lshrrev_b32 v9, 5, v13
    v_bfe_u32 v10, v13, 1, 3
    v_lshlrev_b32 v11, 2, v9
    v_xor_b32 v10, v10, v11
    v_lshlrev_b32 v11, 7, v8

    v_add_u32 v11, s33, v11
    v_xor_b32 v12, 0, v10
    v_lshl_add_u32 v136, v12, 4, v11
    v_xor_b32 v12, 1, v10
    v_lshl_add_u32 v137, v12, 4, v11
    v_xor_b32 v12, 2, v10
    v_lshl_add_u32 v138, v12, 4, v11
    v_xor_b32 v12, 3, v10
    v_lshl_add_u32 v139, v12, 4, v11
    v_lshlrev_b32 v144, 4, v9
    v_lshlrev_b32 v1, 2, v8
    v_add_u32 v145, 32960, v1
    v_bfe_u32 v10, v8, 2, 1
    v_cmp_eq_u32 vcc, v10, v9
    v_mov_b32 v11, 0x3f803f80
    v_mov_b32 v12, 0
    v_cndmask_b32 v112, v12, v11, vcc
    v_mov_b32 v116, v112
    v_cmp_eq_u32 vcc, 0, v9
    v_mov_b32 v11, 0x3f80
    v_mov_b32 v113, 0
    v_mov_b32 v114, 0
    v_mov_b32 v115, 0
    v_mov_b32 v121, 0x7149
    v_mov_b32 v122, 0
    v_mov_b32 v123, 0
    v_mov_b32 v117, 0
    v_mov_b32 v118, 0
    v_mov_b32 v119, 0
    v_mov_b32 v125, 0x7149
    v_mov_b32 v126, 0
    v_mov_b32 v127, 0
    v_cndmask_b32 v155, v12, v11, vcc
    v_mov_b32 v14, 1.0
    v_mov_b32 v15, 1.0
    v_mov_b32 v4, -1
    s_lshl_b32 s80, s28, 8
    s_add_u32 m0, s80, 3392
    s_nop 0
    ds_write_addtid_b32 v4 offset:0
    ds_write_addtid_b32 v4 offset:2048
    ds_write_addtid_b32 v4 offset:4096
    ds_write_addtid_b32 v4 offset:6144
    ds_write_addtid_b32 v4 offset:8192
    ds_write_addtid_b32 v4 offset:10240
    ds_write_addtid_b32 v4 offset:12288
    ds_write_addtid_b32 v4 offset:14336
    ds_write_addtid_b32 v4 offset:16384
    ds_write_addtid_b32 v4 offset:18432
    ds_write_addtid_b32 v4 offset:20480
    ds_write_addtid_b32 v4 offset:22528
    ds_write_addtid_b32 v4 offset:24576
    ds_write_addtid_b32 v4 offset:26624
    s_cmp_gt_u32 s28, 3
    s_cbranch_scc1 K3_PF_1
    s_cmp_eq_u32 s28, 3
    s_cselect_b32 exec_hi, 0, -1
    ds_write_addtid_b32 v4 offset:28672
    s_mov_b32 exec_hi, -1
K3_PF_1:
    v_lshlrev_b32 v8, 4, v0
    v_mov_b32 v4, 0
    v_mov_b32 v5, 0
    v_mov_b32 v6, 0
    v_mov_b32 v7, 0
    v_cmp_gt_u32 vcc, 82, v0
    s_and_saveexec_b64 s[38:39], vcc
    ds_write_b128 v8, v[4:7] offset:2080
    s_mov_b64 exec, s[38:39]
    v_mov_b32 v4, 0
    s_mul_i32 s80, s28, 1280
    s_add_u32 m0, s80, 33216
    s_nop 0
    ds_write_addtid_b32 v4 offset:0
    ds_write_addtid_b32 v4 offset:256
    ds_write_addtid_b32 v4 offset:512
    ds_write_addtid_b32 v4 offset:768
    ds_write_addtid_b32 v4 offset:10240
    ds_write_addtid_b32 v4 offset:10496
    ds_write_addtid_b32 v4 offset:10752
    ds_write_addtid_b32 v4 offset:11008
    ds_write_addtid_b32 v4 offset:20480
    ds_write_addtid_b32 v4 offset:20736
    ds_write_addtid_b32 v4 offset:20992
    ds_write_addtid_b32 v4 offset:21248
    ds_write_addtid_b32 v4 offset:30720
    ds_write_addtid_b32 v4 offset:30976
    ds_write_addtid_b32 v4 offset:31232
    ds_write_addtid_b32 v4 offset:31488
    ds_write_addtid_b32 v4 offset:40960
    ds_write_addtid_b32 v4 offset:41216
    ds_write_addtid_b32 v4 offset:41472
    ds_write_addtid_b32 v4 offset:41728
    ds_write_addtid_b32 v4 offset:51200
    ds_write_addtid_b32 v4 offset:51456
    ds_write_addtid_b32 v4 offset:51712
    ds_write_addtid_b32 v4 offset:51968
    s_cmp_gt_u32 s28, 1
    s_cbranch_scc1 K3_NZ_2
    ds_write_addtid_b32 v4 offset:61440
    ds_write_addtid_b32 v4 offset:61696
    ds_write_addtid_b32 v4 offset:61952
    ds_write_addtid_b32 v4 offset:62208
    s_mov_b32 m0, 32960
    s_nop 0
    ds_write_addtid_b32 v4
K3_NZ_2:
K3_HIST:
    s_waitcnt vmcnt(0)
    v_mov_b32 v8, 1
    v_mov_b32 v10, 44
    v_mov_b32 v11, 97024
    v_mov_b32 v96, 0
    s_mov_b32 s8, 0
    s_cmp_eq_u32 s32, 3
    s_cbranch_scc1 K3_NOHIGH
    v_mov_b32 v24, 0
    v_mov_b32 v25, 0
    v_mov_b32 v26, 0
    v_mov_b32 v27, 0
    v_mov_b32 v28, 0
    v_mov_b32 v29, 0
    v_mov_b32 v30, 0
    v_mov_b32 v31, 0
    s_mov_b32 s80, 0x400000
    v_and_b32 v9, 63, v17
    v_cmp_eq_u32 vcc, 62, v9
    s_cbranch_vccz K3_HI_3
    s_lshr_b64 s[82:83], vcc, 7
    s_lshl_b64 s[84:85], s[82:83], 8
    s_sub_u32 s82, s84, s82
    s_subb_u32 s83, s85, s83
    s_mov_b64 exec, vcc
    v_mov_b32 v17, 0
    s_mov_b64 exec, s[82:83]
    buffer_load_dwordx2 v[24:25], v164, s[40:43], s80 offen
    s_mov_b64 exec, -1
K3_HI_3:
    v_and_b32 v9, 63, v19
    v_cmp_eq_u32 vcc, 62, v9
    s_cbranch_vccz K3_HI_4
    s_lshr_b64 s[82:83], vcc, 7
    s_lshl_b64 s[84:85], s[82:83], 8
    s_sub_u32 s82, s84, s82
    s_subb_u32 s83, s85, s83
    s_mov_b64 exec, vcc
    v_mov_b32 v19, 0
    s_mov_b64 exec, s[82:83]
    buffer_load_dwordx2 v[26:27], v165, s[40:43], s80 offen
    s_mov_b64 exec, -1
K3_HI_4:
    v_and_b32 v9, 63, v21
    v_cmp_eq_u32 vcc, 62, v9
    s_cbranch_vccz K3_HI_5
    s_lshr_b64 s[82:83], vcc, 7
    s_lshl_b64 s[84:85], s[82:83], 8
    s_sub_u32 s82, s84, s82
    s_subb_u32 s83, s85, s83
    s_mov_b64 exec, vcc
    v_mov_b32 v21, 0
    s_mov_b64 exec, s[82:83]
    buffer_load_dwordx2 v[28:29], v166, s[40:43], s80 offen
    s_mov_b64 exec, -1
K3_HI_5:
    v_and_b32 v9, 63, v23
    v_cmp_eq_u32 vcc, 62, v9
    s_cbranch_vccz K3_HI_6
    s_lshr_b64 s[82:83], vcc, 7
    s_lshl_b64 s[84:85], s[82:83], 8
    s_sub_u32 s82, s84, s82
    s_subb_u32 s83, s85, s83
    s_mov_b64 exec, vcc
    v_mov_b32 v23, 0
    s_mov_b64 exec, s[82:83]
    buffer_load_dwordx2 v[30:31], v167, s[40:43], s80 offen
    s_mov_b64 exec, -1
K3_HI_6:
K3_NOHIGH:
    v_and_b32 v9, 63, v16
    v_mad_u32_u24 v32, v9, v10, v11
    v_cmp_ne_u32 s[48:49], 0, v9
    v_and_b32 v9, 63, v17
    v_mad_u32_u24 v33, v9, v10, v11
    v_cmp_ne_u32 s[50:51], 0, v9
    v_and_b32 v9, 63, v18
    v_mad_u32_u24 v34, v9, v10, v11
    v_cmp_ne_u32 s[52:53], 0, v9
    v_and_b32 v9, 63, v19
    v_mad_u32_u24 v35, v9, v10, v11
    v_cmp_ne_u32 s[54:55], 0, v9
    v_and_b32 v9, 63, v20
    v_mad_u32_u24 v36, v9, v10, v11
    v_cmp_ne_u32 s[56:57], 0, v9
    v_and_b32 v9, 63, v21
    v_mad_u32_u24 v37, v9, v10, v11
    v_cmp_ne_u32 s[58:59], 0, v9
    v_and_b32 v9, 63, v22
    v_mad_u32_u24 v38, v9, v10, v11
    v_cmp_ne_u32 s[60:61], 0, v9
    v_and_b32 v9, 63, v23
    v_mad_u32_u24 v39, v9, v10, v11
    v_cmp_ne_u32 s[62:63], 0, v9
    s_mov_b64 exec, s[48:49]
    ds_add_rtn_u32 v48, v32, v8 offset:40
    s_mov_b64 exec, s[50:51]
    ds_add_rtn_u32 v49, v33, v8 offset:40
    s_mov_b64 exec, s[52:53]
    ds_add_rtn_u32 v50, v34, v8 offset:40
    s_mov_b64 exec, s[54:55]
    ds_add_rtn_u32 v51, v35, v8 offset:40
    s_mov_b64 exec, s[56:57]
    ds_add_rtn_u32 v52, v36, v8 offset:40
    s_mov_b64 exec, s[58:59]
    ds_add_rtn_u32 v53, v37, v8 offset:40
    s_mov_b64 exec, s[60:61]
    ds_add_rtn_u32 v54, v38, v8 offset:40
    s_mov_b64 exec, s[62:63]
    ds_add_rtn_u32 v55, v39, v8 offset:40
    s_mov_b64 exec, -1
    s_mul_i32 s80, s30, 1
    v_add_u32 v81, s80, v3
    s_mul_i32 s80, s30, 2
    v_add_u32 v82, s80, v3
    s_mul_i32 s80, s30, 3
    v_add_u32 v83, s80, v3
    v_mov_b32 v80, v3
    v_bfe_u32 v64, v16, 6, 12
    v_add_u32 v64, v64, v80
    v_bfe_u32 v65, v17, 6, 12
    v_add_u32 v65, v65, v80
    v_bfe_u32 v66, v18, 6, 12
    v_add_u32 v66, v66, v81
    v_bfe_u32 v67, v19, 6, 12
    v_add_u32 v67, v67, v81
    v_bfe_u32 v68, v20, 6, 12
    v_add_u32 v68, v68, v82
    v_bfe_u32 v69, v21, 6, 12
    v_add_u32 v69, v69, v82
    v_bfe_u32 v70, v22, 6, 12
    v_add_u32 v70, v70, v83
    v_bfe_u32 v71, v23, 6, 12
    v_add_u32 v71, v71, v83
    s_cmp_lg_u32 s32, 0
    s_cbranch_scc1 K3_NODMA
    s_lshl_b32 s80, s28, 10
    s_add_u32 m0, s80, 101120
    s_nop 0
    buffer_load_dwordx4 v128, s[12:15], 0 offen lds
    s_add_u32 s80, s28, 0
    s_cmp_ge_u32 s80, 18
    s_cselect_b32 s82, 4294928384, 0
    s_lshl_b32 s80, s80, 10
    s_add_u32 s82, s82, s80
    s_add_u32 m0, s82, 129792
    s_add_u32 s80, s80, 12582912
    buffer_load_dwordx4 v129, s[20:23], s80 offen lds
    s_add_u32 s80, s28, 8
    s_cmp_ge_u32 s80, 18
    s_cselect_b32 s82, 4294928384, 0
    s_lshl_b32 s80, s80, 10
    s_add_u32 s82, s82, s80
    s_add_u32 m0, s82, 129792
    s_add_u32 s80, s80, 12582912
    buffer_load_dwordx4 v129, s[20:23], s80 offen lds
    s_add_u32 s80, s28, 16
    s_cmp_ge_u32 s80, 18
    s_cselect_b32 s82, 4294928384, 0
    s_lshl_b32 s80, s80, 10
    s_add_u32 s82, s82, s80
    s_add_u32 m0, s82, 129792
    s_add_u32 s80, s80, 12582912
    buffer_load_dwordx4 v129, s[20:23], s80 offen lds
    s_add_u32 s80, s28, 24
    s_cmp_ge_u32 s80, 18
    s_cselect_b32 s82, 4294928384, 0
    s_lshl_b32 s80, s80, 10
    s_add_u32 s82, s82, s80
    s_add_u32 m0, s82, 129792
    s_add_u32 s80, s80, 12582912
    buffer_load_dwordx4 v129, s[20:23], s80 offen lds
    s_add_u32 s80, s28, 32
    s_cmp_ge_u32 s80, 34
    s_cbranch_scc1 K3_WSK_11
    s_cmp_ge_u32 s80, 18
    s_cselect_b32 s82, 4294928384, 0
    s_lshl_b32 s80, s80, 10
    s_add_u32 s82, s82, s80
    s_add_u32 m0, s82, 129792
    s_add_u32 s80, s80, 12582912
    buffer_load_dwordx4 v129, s[20:23], s80 offen lds
K3_WSK_11:
    buffer_load_dwordx4 v[160:163], v130, s[12:15], 0 offen
K3_NODMA:
    s_waitcnt lgkmcnt(0)
    v_lshrrev_b32 v9, 2, v48
    v_lshrrev_b32 v16, 18, v16
    v_and_b32 v9, -4, v9
    v_add_u32 v32, v9, v32
    v_lshrrev_b32 v9, 2, v49
    v_lshrrev_b32 v17, 18, v17
    v_and_b32 v9, -4, v9
    v_add_u32 v33, v9, v33
    v_lshrrev_b32 v9, 2, v50
    v_lshrrev_b32 v18, 18, v18
    v_and_b32 v9, -4, v9
    v_add_u32 v34, v9, v34
    v_lshrrev_b32 v9, 2, v51
    v_lshrrev_b32 v19, 18, v19
    v_and_b32 v9, -4, v9
    v_add_u32 v35, v9, v35
    v_lshrrev_b32 v9, 2, v52
    v_lshrrev_b32 v20, 18, v20
    v_and_b32 v9, -4, v9
    v_add_u32 v36, v9, v36
    v_lshrrev_b32 v9, 2, v53
    v_lshrrev_b32 v21, 18, v21
    v_and_b32 v9, -4, v9
    v_add_u32 v37, v9, v37
    v_lshrrev_b32 v9, 2, v54
    v_lshrrev_b32 v22, 18, v22
    v_and_b32 v9, -4, v9
    v_add_u32 v38, v9, v38
    v_lshrrev_b32 v9, 2, v55
    v_lshrrev_b32 v23, 18, v23
    v_and_b32 v9, -4, v9
    v_add_u32 v39, v9, v39
    v_lshrrev_b32 v12, 5, v13
    v_bfe_u32 v9, v13, 3, 2
    v_lshlrev_b32 v9, 2, v9
    v_lshl_add_u32 v12, v12, 5, v9
    v_add_u32 v164, 3392, v12
    v_bfe_u32 v12, v13, 2, 1
    v_bfe_u32 v9, v13, 4, 1
    v_lshlrev_b32 v12, 4, v12
    v_lshl_add_u32 v12, v9, 3, v12
    v_and_b32 v9, 3, v13
    v_lshl_add_u32 v12, v9, 1, v12
    v_bfe_u32 v9, v13, 3, 1
    v_add_u32 v12, v12, v9

    v_lshlrev_b32 v165, 2, v12
    v_lshrrev_b32 v12, 5, v13
    v_lshlrev_b32 v166, 2, v12
    s_cmp_lg_u32 s32, 0
    s_cbranch_scc1 K3_WH0
    s_waitcnt vmcnt(6)
    s_branch K3_WH1
K3_WH0:
    s_waitcnt vmcnt(0)
K3_WH1:
    s_mov_b64 s[6:7], 0
    v_and_b32 v9, 63, v25
    v_cmp_eq_u32 vcc, 63, v9
    s_or_b64 s[6:7], s[6:7], vcc
    v_and_b32 v9, 63, v27
    v_cmp_eq_u32 vcc, 63, v9
    s_or_b64 s[6:7], s[6:7], vcc
    v_and_b32 v9, 63, v29
    v_cmp_eq_u32 vcc, 63, v9
    s_or_b64 s[6:7], s[6:7], vcc
    v_and_b32 v9, 63, v31
    v_cmp_eq_u32 vcc, 63, v9
    s_or_b64 s[6:7], s[6:7], vcc
    s_cmp_lg_u64 s[6:7], 0
    s_cbranch_scc1 K3_INLINE
K3_INLINEDONE:
    v_and_b32 v9, 63, v24
    v_mad_u32_u24 v40, v9, v10, v11
    v_cmp_ne_u32 s[64:65], 0, v9
    v_and_b32 v9, 63, v25
    v_mad_u32_u24 v41, v9, v10, v11
    v_cmp_ne_u32 s[66:67], 0, v9
    v_and_b32 v9, 63, v26
    v_mad_u32_u24 v42, v9, v10, v11
    v_cmp_ne_u32 s[68:69], 0, v9
    v_and_b32 v9, 63, v27
    v_mad_u32_u24 v43, v9, v10, v11
    v_cmp_ne_u32 s[70:71], 0, v9
    v_and_b32 v9, 63, v28
    v_mad_u32_u24 v44, v9, v10, v11
    v_cmp_ne_u32 s[72:73], 0, v9
    v_and_b32 v9, 63, v29
    v_mad_u32_u24 v45, v9, v10, v11
    v_cmp_ne_u32 s[74:75], 0, v9
    v_and_b32 v9, 63, v30
    v_mad_u32_u24 v46, v9, v10, v11
    v_cmp_ne_u32 s[76:77], 0, v9
    v_and_b32 v9, 63, v31
    v_mad_u32_u24 v47, v9, v10, v11
    v_cmp_ne_u32 s[78:79], 0, v9
    s_mov_b64 exec, s[64:65]
    ds_add_rtn_u32 v56, v40, v8 offset:40
    s_mov_b64 exec, s[66:67]
    ds_add_rtn_u32 v57, v41, v8 offset:40
    s_mov_b64 exec, s[68:69]
    ds_add_rtn_u32 v58, v42, v8 offset:40
    s_mov_b64 exec, s[70:71]
    ds_add_rtn_u32 v59, v43, v8 offset:40
    s_mov_b64 exec, s[72:73]
    ds_add_rtn_u32 v60, v44, v8 offset:40
    s_mov_b64 exec, s[74:75]
    ds_add_rtn_u32 v61, v45, v8 offset:40
    s_mov_b64 exec, s[76:77]
    ds_add_rtn_u32 v62, v46, v8 offset:40
    s_mov_b64 exec, s[78:79]
    ds_add_rtn_u32 v63, v47, v8 offset:40
    s_mov_b64 exec, -1
    v_and_b32 v9, 63, v96
    v_mad_u32_u24 v97, v9, v10, v11
    v_cmp_ne_u32 s[6:7], 0, v9
    s_mov_b64 exec, s[6:7]
    ds_add_rtn_u32 v98, v97, v8 offset:40
    s_mov_b64 exec, -1
    v_bfe_u32 v72, v24, 6, 12
    v_add_u32 v72, v72, v80
    v_bfe_u32 v73, v25, 6, 12
    v_add_u32 v73, v73, v80
    v_bfe_u32 v74, v26, 6, 12
    v_add_u32 v74, v74, v81
    v_bfe_u32 v75, v27, 6, 12
    v_add_u32 v75, v75, v81
    v_bfe_u32 v76, v28, 6, 12
    v_add_u32 v76, v76, v82
    v_bfe_u32 v77, v29, 6, 12
    v_add_u32 v77, v77, v82
    v_bfe_u32 v78, v30, 6, 12
    v_add_u32 v78, v78, v83
    v_bfe_u32 v79, v31, 6, 12
    v_add_u32 v79, v79, v83
    v_bfe_u32 v99, v96, 6, 12
    v_add_u32 v99, s8, v99
    s_waitcnt lgkmcnt(0)
    s_barrier
    v_mad_u32_u24 v9, v13, v10, v11
    ds_read_b32 v128, v9 offset:40
    s_cmp_lg_u32 s32, 0
    s_cbranch_scc1 K3_NOPF
    v_lshlrev_b32 v12, 7, v0
    s_lshr_b32 s80, s2, 3
    s_mul_i32 s80, s80, 50048
    s_add_u32 s80, s80, 3072
    v_cmp_gt_u32 vcc, 0x187, v0
    v_bfrev_b32 v156, 1
    s_nop 0
    v_cndmask_b32 v156, v156, v12, vcc
    buffer_load_dword v156, v156, s[12:15], s80 offen
K3_NOPF:
    s_waitcnt lgkmcnt(0)
    v_mul_u32_u24 v130, 1280, v13
    v_readlane_b32 s87, v128, 63
    v_cmp_gt_u32 vcc, 50, v13
    s_nop 1
    v_cndmask_b32 v128, 0, v128, vcc
    v_and_b32 v8, 15, v128
    v_cmp_gt_u32 vcc, 0x80, v128
    v_subrev_u32 v8, 1, v8
    s_mov_b64 s[82:83], vcc
    v_cmp_gt_u32 vcc, 8, v8
    v_add_u32 v129, 15, v128
    v_lshrrev_b32 v10, 4, v128
    s_and_b64 s[20:21], vcc, s[82:83]
    v_lshrrev_b32 v129, 4, v129
    s_bcnt1_i32_b64 s9, s[20:21]
    v_mbcnt_lo_u32_b32 v11, s20, 0
    v_mbcnt_hi_u32_b32 v11, s21, v11
    s_cmp_gt_u32 s9, 32
    s_cbranch_scc1 K3_MIXCAP
K3_MIXCAPDONE:
    v_cndmask_b32 v129, v129, v10, s[20:21]
    s_add_u32 s9, s9, 1
    s_lshr_b32 s9, s9, 1
    v_cmp_lt_u32 s[4:5], 0, v129
    v_cmp_lt_u32 s[10:11], 1, v129
    v_cmp_lt_u32 s[44:45], 2, v129
    v_cmp_lt_u32 s[38:39], 3, v129
    v_cmp_lt_u32 s[82:83], 4, v129
    v_cmp_lt_u32 s[84:85], 5, v129
    v_cmp_lt_u32 s[36:37], 6, v129
    v_cmp_lt_u32 vcc, 7, v129
    s_mov_b32 s81, s9
    s_mov_b32 s86, s9
    s_bcnt1_i32_b64 s80, s[4:5]
    s_cmp_gt_u32 s28, 0
    s_cselect_b32 s9, s80, 0
    s_add_u32 s81, s81, s80
    s_add_u32 s86, s86, s9
    s_bcnt1_i32_b64 s80, s[10:11]
    s_cmp_gt_u32 s28, 1
    s_cselect_b32 s9, s80, 0
    s_add_u32 s81, s81, s80
    s_add_u32 s86, s86, s9
    s_bcnt1_i32_b64 s80, s[44:45]
    s_cmp_gt_u32 s28, 2
    s_cselect_b32 s9, s80, 0
    s_add_u32 s81, s81, s80
    s_add_u32 s86, s86, s9
    s_bcnt1_i32_b64 s80, s[38:39]
    s_cmp_gt_u32 s28, 3
    s_cselect_b32 s9, s80, 0
    s_add_u32 s81, s81, s80
    s_add_u32 s86, s86, s9
    s_bcnt1_i32_b64 s80, s[82:83]
    s_cmp_gt_u32 s28, 4
    s_cselect_b32 s9, s80, 0
    s_add_u32 s81, s81, s80
    s_add_u32 s86, s86, s9
    s_bcnt1_i32_b64 s80, s[84:85]
    s_cmp_gt_u32 s28, 5
    s_cselect_b32 s9, s80, 0
    s_add_u32 s81, s81, s80
    s_add_u32 s86, s86, s9
    s_bcnt1_i32_b64 s80, s[36:37]
    s_cmp_gt_u32 s28, 6
    s_cselect_b32 s9, s80, 0
    s_add_u32 s81, s81, s80
    s_add_u32 s86, s86, s9
    s_bcnt1_i32_b64 s80, vcc
    s_cmp_gt_u32 s28, 7
    s_cselect_b32 s9, s80, 0
    s_add_u32 s81, s81, s80
    s_add_u32 s86, s86, s9
    v_cmp_lt_u32 s[4:5], s28, v129
    v_cmp_lt_u32 vcc, 8, v129
    s_mov_b32 s36, 0
    s_cbranch_vccnz K3_TAIL
K3_TAILDONE:
    s_cmp_gt_u32 s81, 307
    s_cbranch_scc1 K3_SPLIT
    s_cmp_lg_u32 s87, 0
    s_cbranch_scc1 K3_MARKERS
K3_MARKDONE:
    v_mbcnt_lo_u32_b32 v131, s4, 0
    v_mbcnt_hi_u32_b32 v131, s5, v131
    s_lshl_b32 s80, s28, 4
    v_subrev_u32 v132, s80, v128
    v_add_u32 v131, s86, v131
    v_min_u32 v132, 16, v132
    v_lshlrev_b32 v133, 2, v131
    v_lshl_add_u32 v132, v132, 22, v130
    v_cmp_gt_u32 vcc, 16, v131
    s_and_b64 s[82:83], vcc, s[4:5]
    v_subrev_u32 v131, s28, v131
    v_lshlrev_b32 v131, 6, v131
    v_cmp_eq_u32 vcc, s28, v10
    s_and_b64 s[84:85], vcc, s[20:21]
    s_lshl_b32 s80, s28, 6
    v_lshlrev_b32 v12, 5, v11
    v_subrev_u32 v12, s80, v12
    v_cndmask_b32 v131, v131, v12, s[84:85]
    s_lshl_b32 s80, s28, 2
    v_add_u32 v9, s80, v9
    ds_write_b32 v9, v131
    s_cmp_lg_u32 s36, 0
    s_cbranch_scc1 K3_TAILDESC
K3_TAILDESCDONE:
    s_add_u32 s81, s81, 1
    s_lshr_b32 s31, s81, 1
    s_cmp_lg_u32 s36, 0
    s_cbranch_scc1 K3_CLAMP
    v_lshrrev_b32 v9, 2, v56
    v_lshrrev_b32 v24, 18, v24
    v_and_b32 v9, -4, v9
    v_add_u32 v40, v9, v40
    v_lshrrev_b32 v9, 2, v57
    v_lshrrev_b32 v25, 18, v25
    v_and_b32 v9, -4, v9
    v_add_u32 v41, v9, v41
    v_lshrrev_b32 v9, 2, v58
    v_lshrrev_b32 v26, 18, v26
    v_and_b32 v9, -4, v9
    v_add_u32 v42, v9, v42
    v_lshrrev_b32 v9, 2, v59
    v_lshrrev_b32 v27, 18, v27
    v_and_b32 v9, -4, v9
    v_add_u32 v43, v9, v43
    v_lshrrev_b32 v9, 2, v60
    v_lshrrev_b32 v28, 18, v28
    v_and_b32 v9, -4, v9
    v_add_u32 v44, v9, v44
    v_lshrrev_b32 v9, 2, v61
    v_lshrrev_b32 v29, 18, v29
    v_and_b32 v9, -4, v9
    v_add_u32 v45, v9, v45
    v_lshrrev_b32 v9, 2, v62
    v_lshrrev_b32 v30, 18, v30
    v_and_b32 v9, -4, v9
    v_add_u32 v46, v9, v46
    v_lshrrev_b32 v9, 2, v63
    v_lshrrev_b32 v31, 18, v31
    v_and_b32 v9, -4, v9
    v_add_u32 v47, v9, v47
K3_CLAMPDONE:
    v_lshrrev_b32 v9, 4, v98
    v_min_u32 v9, 8, v9
    v_lshl_add_u32 v97, v9, 2, v97
    v_lshrrev_b32 v96, 18, v96
    s_waitcnt vmcnt(1) lgkmcnt(0)
    s_barrier
    ds_read_b32 v97, v97
    ds_read_b32 v32, v32
    ds_read_b32 v33, v33
    ds_read_b32 v34, v34
    ds_read_b32 v35, v35
    ds_read_b32 v36, v36
    ds_read_b32 v37, v37
    ds_read_b32 v38, v38
    ds_read_b32 v39, v39
    ds_read_b32 v40, v40
    ds_read_b32 v41, v41
    ds_read_b32 v42, v42
    ds_read_b32 v43, v43
    ds_read_b32 v44, v44
    ds_read_b32 v45, v45
    ds_read_b32 v46, v46
    ds_read_b32 v47, v47
    s_mov_b64 exec, s[4:5]
    ds_write_b32 v133, v132 offset:2144
    s_mov_b64 exec, s[82:83]
    ds_write_b32 v133, v132 offset:2080
    s_mov_b64 exec, s[20:21]
    v_lshrrev_b32 v12, 1, v11
    v_lshlrev_b32 v12, 2, v12
    v_and_b32 v8, 1, v11
    v_lshlrev_b32 v8, 6, v8
    v_sub_u32 v12, v12, v8
    v_add_u32 v12, 2144, v12
    ds_write_b32 v12, v130
    s_mov_b64 exec, -1
    s_waitcnt lgkmcnt(8)
    v_lshl_add_u32 v32, v48, 2, v32
    v_lshrrev_b32 v48, 1, v32
    v_lshl_add_u32 v33, v49, 2, v33
    v_lshrrev_b32 v49, 1, v33
    v_lshl_add_u32 v34, v50, 2, v34
    v_lshrrev_b32 v50, 1, v34
    v_lshl_add_u32 v35, v51, 2, v35
    v_lshrrev_b32 v51, 1, v35
    v_lshl_add_u32 v36, v52, 2, v36
    v_lshrrev_b32 v52, 1, v36
    v_lshl_add_u32 v37, v53, 2, v37
    v_lshrrev_b32 v53, 1, v37
    v_lshl_add_u32 v38, v54, 2, v38
    v_lshrrev_b32 v54, 1, v38
    v_lshl_add_u32 v39, v55, 2, v39
    v_lshrrev_b32 v55, 1, v39
    s_waitcnt lgkmcnt(0)
    v_lshl_add_u32 v40, v56, 2, v40
    v_lshrrev_b32 v56, 1, v40
    v_lshl_add_u32 v41, v57, 2, v41
    v_lshrrev_b32 v57, 1, v41
    v_lshl_add_u32 v42, v58, 2, v42
    v_lshrrev_b32 v58, 1, v42
    v_lshl_add_u32 v43, v59, 2, v43
    v_lshrrev_b32 v59, 1, v43
    v_lshl_add_u32 v44, v60, 2, v44
    v_lshrrev_b32 v60, 1, v44
    v_lshl_add_u32 v45, v61, 2, v45
    v_lshrrev_b32 v61, 1, v45
    v_lshl_add_u32 v46, v62, 2, v46
    v_lshrrev_b32 v62, 1, v46
    v_lshl_add_u32 v47, v63, 2, v47
    v_lshrrev_b32 v63, 1, v47
    v_lshl_add_u32 v97, v98, 2, v97
    v_lshrrev_b32 v98, 1, v97
    s_mov_b64 exec, s[48:49]
    ds_write_b32 v32, v64 offset:13248
    ds_write_b16 v48, v16 offset:3392
    s_mov_b64 exec, s[50:51]
    ds_write_b32 v33, v65 offset:13248
    ds_write_b16 v49, v17 offset:3392
    s_mov_b64 exec, s[52:53]
    ds_write_b32 v34, v66 offset:13248
    ds_write_b16 v50, v18 offset:3392
    s_mov_b64 exec, s[54:55]
    ds_write_b32 v35, v67 offset:13248
    ds_write_b16 v51, v19 offset:3392
    s_mov_b64 exec, s[56:57]
    ds_write_b32 v36, v68 offset:13248
    ds_write_b16 v52, v20 offset:3392
    s_mov_b64 exec, s[58:59]
    ds_write_b32 v37, v69 offset:13248
    ds_write_b16 v53, v21 offset:3392
    s_mov_b64 exec, s[60:61]
    ds_write_b32 v38, v70 offset:13248
    ds_write_b16 v54, v22 offset:3392
    s_mov_b64 exec, s[62:63]
    ds_write_b32 v39, v71 offset:13248
    ds_write_b16 v55, v23 offset:3392
    s_mov_b64 exec, s[64:65]
    ds_write_b32 v40, v72 offset:13248
    ds_write_b16 v56, v24 offset:3392
    s_mov_b64 exec, s[66:67]
    ds_write_b32 v41, v73 offset:13248
    ds_write_b16 v57, v25 offset:3392
    s_mov_b64 exec, s[68:69]
    ds_write_b32 v42, v74 offset:13248
    ds_write_b16 v58, v26 offset:3392
    s_mov_b64 exec, s[70:71]
    ds_write_b32 v43, v75 offset:13248
    ds_write_b16 v59, v27 offset:3392
    s_mov_b64 exec, s[72:73]
    ds_write_b32 v44, v76 offset:13248
    ds_write_b16 v60, v28 offset:3392
    s_mov_b64 exec, s[74:75]
    ds_write_b32 v45, v77 offset:13248
    ds_write_b16 v61, v29 offset:3392
    s_mov_b64 exec, s[76:77]
    ds_write_b32 v46, v78 offset:13248
    ds_write_b16 v62, v30 offset:3392
    s_mov_b64 exec, s[78:79]
    ds_write_b32 v47, v79 offset:13248
    ds_write_b16 v63, v31 offset:3392
    s_mov_b64 exec, s[6:7]
    ds_write_b32 v97, v99 offset:13248
    ds_write_b16 v98, v96 offset:3392
    s_mov_b64 exec, -1
    s_cmp_lg_u32 s32, 0
    s_cbranch_scc1 K3_NOOPR
    s_bfe_u32 s38, s28, 0x10001
    s_lshl_b32 s80, s38, 12
    s_add_u32 s80, s80, 101120
    s_sub_u32 s80, s80, s33
    v_add_u32 v12, s80, v136
    ds_read_b128 v[80:83], v12
    v_add_u32 v12, s80, v137
    ds_read_b128 v[84:87], v12
    v_add_u32 v12, s80, v138
    ds_read_b128 v[88:91], v12
    v_add_u32 v12, s80, v139
    ds_read_b128 v[92:95], v12
    s_and_b32 s37, s28, 1
    s_lshr_b32 s39, s28, 2
    s_lshl_b32 s80, s37, 13
    s_lshl_b32 s81, s39, 10
    s_add_u32 s80, s80, s81
    s_add_u32 s80, s80, 109312
    v_lshlrev_b32 v12, 4, v13
    v_add_u32 v12, s80, v12
    ds_read_b128 v[96:99], v12 offset:0
    ds_read_b128 v[100:103], v12 offset:2048
    ds_read_b128 v[104:107], v12 offset:4096
    ds_read_b128 v[108:111], v12 offset:6144
K3_NOOPR:
    v_mov_b32 v13, 1
    s_mov_b32 s44, s28
    s_add_u32 s45, s28, 8
    s_lshl_b32 s80, s44, 6
    s_lshl_b32 s81, s44, 7
    v_add_u32 v146, s80, v164
    v_add_u32 v147, s81, v165
    s_waitcnt lgkmcnt(0)
    s_barrier
    ds_read2_b32 v[150:151], v146 offset0:0 offset1:4
    ds_read_b32 v152, v147 offset:13248
    s_lshl_b32 s80, s44, 3
    v_add_u32 v148, s80, v166
    ds_read_b32 v153, v148 offset:2144
    ds_read_b32 v149, v148 offset:2080
    s_mov_b64 exec, 1
    ds_add_rtn_u32 v167, v1, v13 offset:4
    s_mov_b64 exec, -1
    s_waitcnt lgkmcnt(3)
    s_mov_b32 m0, s33
    v_mad_u32_u16 v8, v150, s35, v140
    v_mad_u32_u16 v9, v150, s35, v141 op_sel:[1,0,0,0]
    v_mad_u32_u16 v10, v151, s35, v142
    v_mad_u32_u16 v11, v151, s35, v143 op_sel:[1,0,0,0]
    v_lshl_add_u32 v12, v152, 5, v144
    v_and_b32_sdwa v113, v152, v155 dst_sel:DWORD dst_unused:UNUSED_PAD src0_sel:WORD_1 src1_sel:DWORD
    buffer_load_dwordx4 v8, s[12:15], 0 offen offset:0 lds
    buffer_load_dwordx4 v9, s[12:15], 0 offen offset:1024 lds
    buffer_load_dwordx4 v10, s[12:15], 0 offen offset:2048 lds
    buffer_load_dwordx4 v11, s[12:15], 0 offen offset:3072 lds
    buffer_load_dwordx4 v[128:131], v12, s[16:19], 0 offen
    s_lshl_b32 s80, s45, 6
    s_lshl_b32 s81, s45, 7
    v_add_u32 v146, s80, v164
    v_add_u32 v147, s81, v165
    ds_read2_b32 v[150:151], v146 offset0:0 offset1:4
    ds_read_b32 v152, v147 offset:13248
    s_cmp_lg_u32 s32, 0
    s_cbranch_scc1 K3_NOW
    v_mfma_f32_32x32x16_bf16 a[72:87], v[80:83], v[96:99], 0
    v_mfma_f32_32x32x16_bf16 a[72:87], v[84:87], v[100:103], a[72:87]
    v_mfma_f32_32x32x16_bf16 a[72:87], v[88:91], v[104:107], a[72:87]
    v_mfma_f32_32x32x16_bf16 a[72:87], v[92:95], v[108:111], a[72:87]
    v_and_b32 v9, 63, v0
    v_lshlrev_b32 v9, 4, v9
    v_add_u32 v9, 129792, v9
    ds_read_b128 a[0:3], v9 offset:0
    ds_read_b128 a[4:7], v9 offset:1024
    ds_read_b128 a[8:11], v9 offset:2048
    ds_read_b128 a[12:15], v9 offset:3072
    ds_read_b128 a[16:19], v9 offset:4096
    ds_read_b128 a[20:23], v9 offset:5120
    ds_read_b128 a[24:27], v9 offset:6144
    ds_read_b128 a[28:31], v9 offset:7168
    ds_read_b128 a[32:35], v9 offset:8192
    ds_read_b128 a[36:39], v9 offset:9216
    ds_read_b128 a[40:43], v9 offset:10240
    ds_read_b128 a[44:47], v9 offset:11264
    ds_read_b128 a[48:51], v9 offset:12288
    ds_read_b128 a[52:55], v9 offset:13312
    ds_read_b128 a[56:59], v9 offset:14336
    ds_read_b128 a[60:63], v9 offset:15360
    ds_read_b128 a[64:67], v9 offset:16384
    ds_read_b128 a[68:71], v9 offset:17408
    s_and_b32 s37, s28, 1
    s_cmp_eq_u32 s37, 1
    s_cbranch_scc1 K3_NOW
    s_bfe_u32 s38, s28, 0x10001
    s_lshr_b32 s39, s28, 2
    s_mul_i32 s80, s38, 40960
    s_lshl_b32 s81, s39, 7
    s_add_u32 s80, s80, s81
    s_add_u32 s80, s80, 1280
    v_bfe_u32 v9, v0, 5, 1
    v_mul_u32_u24 v9, 5120, v9
    v_add_u32 v10, v9, v145
    v_add_u32 v10, s80, v10
    s_nop 7
    s_mov_b32 s81, 0xbfb8aa3b
    v_accvgpr_read_b32 v64, a72
    v_accvgpr_read_b32 v65, a73
    v_accvgpr_read_b32 v66, a74
    v_accvgpr_read_b32 v67, a75
    v_accvgpr_read_b32 v68, a76
    v_accvgpr_read_b32 v69, a77
    v_accvgpr_read_b32 v70, a78
    v_accvgpr_read_b32 v71, a79
    v_accvgpr_read_b32 v72, a80
    v_accvgpr_read_b32 v73, a81
    v_accvgpr_read_b32 v74, a82
    v_accvgpr_read_b32 v75, a83
    v_accvgpr_read_b32 v76, a84
    v_accvgpr_read_b32 v77, a85
    v_accvgpr_read_b32 v78, a86
    v_accvgpr_read_b32 v79, a87
    v_mul_f32 v64, s81, v64
    v_mul_f32 v65, s81, v65
    v_mul_f32 v66, s81, v66
    v_mul_f32 v67, s81, v67
    v_mul_f32 v68, s81, v68
    v_mul_f32 v69, s81, v69
    v_mul_f32 v70, s81, v70
    v_mul_f32 v71, s81, v71
    v_mul_f32 v72, s81, v72
    v_mul_f32 v73, s81, v73
    v_mul_f32 v74, s81, v74
    v_mul_f32 v75, s81, v75
    v_mul_f32 v76, s81, v76
    v_mul_f32 v77, s81, v77
    v_mul_f32 v78, s81, v78
    v_mul_f32 v79, s81, v79
    v_cvt_pk_bf16_f32 v32, v64, v64
    v_cvt_pk_bf16_f32 v33, v65, v65
    v_cvt_pk_bf16_f32 v34, v66, v66
    v_cvt_pk_bf16_f32 v35, v67, v67
    v_cvt_pk_bf16_f32 v36, v68, v68
    v_cvt_pk_bf16_f32 v37, v69, v69
    v_cvt_pk_bf16_f32 v38, v70, v70
    v_cvt_pk_bf16_f32 v39, v71, v71
    v_cvt_pk_bf16_f32 v40, v72, v72
    v_cvt_pk_bf16_f32 v41, v73, v73
    v_cvt_pk_bf16_f32 v42, v74, v74
    v_cvt_pk_bf16_f32 v43, v75, v75
    v_cvt_pk_bf16_f32 v44, v76, v76
    v_cvt_pk_bf16_f32 v45, v77, v77
    v_cvt_pk_bf16_f32 v46, v78, v78
    v_cvt_pk_bf16_f32 v47, v79, v79
    v_lshlrev_b32 v32, 16, v32
    v_lshlrev_b32 v33, 16, v33
    v_lshlrev_b32 v34, 16, v34
    v_lshlrev_b32 v35, 16, v35
    v_lshlrev_b32 v36, 16, v36
    v_lshlrev_b32 v37, 16, v37
    v_lshlrev_b32 v38, 16, v38
    v_lshlrev_b32 v39, 16, v39
    v_lshlrev_b32 v40, 16, v40
    v_lshlrev_b32 v41, 16, v41
    v_lshlrev_b32 v42, 16, v42
    v_lshlrev_b32 v43, 16, v43
    v_lshlrev_b32 v44, 16, v44
    v_lshlrev_b32 v45, 16, v45
    v_lshlrev_b32 v46, 16, v46
    v_lshlrev_b32 v47, 16, v47
    v_sub_f32 v32, v64, v32
    v_sub_f32 v33, v65, v33
    v_sub_f32 v34, v66, v34
    v_sub_f32 v35, v67, v35
    v_sub_f32 v36, v68, v36
    v_sub_f32 v37, v69, v37
    v_sub_f32 v38, v70, v38
    v_sub_f32 v39, v71, v39
    v_sub_f32 v40, v72, v40
    v_sub_f32 v41, v73, v41
    v_sub_f32 v42, v74, v42
    v_sub_f32 v43, v75, v43
    v_sub_f32 v44, v76, v44
    v_sub_f32 v45, v77, v45
    v_sub_f32 v46, v78, v46
    v_sub_f32 v47, v79, v47
    v_cvt_pk_bf16_f32 v64, v64, v32
    v_cvt_pk_bf16_f32 v65, v65, v33
    v_cvt_pk_bf16_f32 v66, v66, v34
    v_cvt_pk_bf16_f32 v67, v67, v35
    v_cvt_pk_bf16_f32 v68, v68, v36
    v_cvt_pk_bf16_f32 v69, v69, v37
    v_cvt_pk_bf16_f32 v70, v70, v38
    v_cvt_pk_bf16_f32 v71, v71, v39
    v_cvt_pk_bf16_f32 v72, v72, v40
    v_cvt_pk_bf16_f32 v73, v73, v41
    v_cvt_pk_bf16_f32 v74, v74, v42
    v_cvt_pk_bf16_f32 v75, v75, v43
    v_cvt_pk_bf16_f32 v76, v76, v44
    v_cvt_pk_bf16_f32 v77, v77, v45
    v_cvt_pk_bf16_f32 v78, v78, v46
    v_cvt_pk_bf16_f32 v79, v79, v47
    ds_write_b32 v10, v64 offset:0
    ds_write_b32 v10, v65 offset:1280
    ds_write_b32 v10, v66 offset:2560
    ds_write_b32 v10, v67 offset:3840
    ds_write_b32 v10, v68 offset:10240
    ds_write_b32 v10, v69 offset:11520
    ds_write_b32 v10, v70 offset:12800
    ds_write_b32 v10, v71 offset:14080
    s_cmp_eq_u32 s38, 1
    s_cbranch_scc1 K3_NW_12
    ds_write_b32 v10, v72 offset:20480
    ds_write_b32 v10, v73 offset:21760
    ds_write_b32 v10, v74 offset:23040
    ds_write_b32 v10, v75 offset:24320
    ds_write_b32 v10, v76 offset:30720
    ds_write_b32 v10, v77 offset:32000
    ds_write_b32 v10, v78 offset:33280
    ds_write_b32 v10, v79 offset:34560
    s_branch K3_NWE_13
K3_NW_12:
    s_mov_b32 exec_hi, 0
    ds_write_b32 v10, v72 offset:20480
    s_mov_b32 exec_hi, -1
K3_NWE_13:
K3_NOW:
    s_waitcnt lgkmcnt(0)
    s_barrier
    s_mov_b32 m0, s34
    v_mad_u32_u16 v8, v150, s35, v140
    v_mad_u32_u16 v9, v150, s35, v141 op_sel:[1,0,0,0]
    v_mad_u32_u16 v10, v151, s35, v142
    v_mad_u32_u16 v11, v151, s35, v143 op_sel:[1,0,0,0]
    v_lshl_add_u32 v12, v152, 5, v144
    v_and_b32_sdwa v117, v152, v155 dst_sel:DWORD dst_unused:UNUSED_PAD src0_sel:WORD_1 src1_sel:DWORD
    buffer_load_dwordx4 v8, s[12:15], 0 offen offset:0 lds
    buffer_load_dwordx4 v9, s[12:15], 0 offen offset:1024 lds
    buffer_load_dwordx4 v10, s[12:15], 0 offen offset:2048 lds
    buffer_load_dwordx4 v11, s[12:15], 0 offen offset:3072 lds
    buffer_load_dwordx4 v[132:135], v12, s[16:19], 0 offen
    v_readfirstlane_b32 s46, v167
    s_lshl_b32 s80, s46, 6
    s_lshl_b32 s81, s46, 7
    v_add_u32 v146, s80, v164
    v_add_u32 v147, s81, v165
    ds_read2_b32 v[150:151], v146 offset0:0 offset1:4
    ds_read_b32 v152, v147 offset:13248
    s_cmp_ge_u32 s44, s31
    s_cbranch_scc1 K3_BATCHEND
    s_mov_b32 s44, s45
    s_mov_b32 s45, s46
    s_waitcnt vmcnt(5)
    v_add_u32_sdwa v154, v153, v145 dst_sel:DWORD dst_unused:UNUSED_PAD src0_sel:WORD_0 src1_sel:DWORD
    v_add_u32 v157, v154, v1
    v_add_u32_sdwa v156, v149, v145 dst_sel:DWORD dst_unused:UNUSED_PAD src0_sel:WORD_0 src1_sel:DWORD
    v_add_u32 v158, v156, v1
    ds_read_b128 v[80:83], v136 offset:0
    ds_read_b128 v[84:87], v137 offset:0
    ds_read_b128 v[88:91], v138 offset:0
    ds_read_b128 v[92:95], v139 offset:0
    ds_read_b32 v120, v154 offset:0
    ds_read_b32 v124, v154 offset:128
    ds_read_b32 v122, v156
    ds_read_b32 v126, v156 offset:128
    v_bfe_u32 v8, v0, 4, 1
    v_cmp_eq_u32 vcc, 0, v8
    v_mov_b32 v9, 0
    s_nop 0
    v_cndmask_b32 v112, v9, v116, vcc
    v_cndmask_b32 v114, v116, v9, vcc
    s_nop 0
    s_waitcnt lgkmcnt(0)
    v_mfma_f32_32x32x16_bf16 v[16:31], v[112:115], v[120:123], 0
    v_mfma_f32_32x32x16_bf16 v[16:31], v[128:131], a[64:67], v[16:31]
    v_mfma_f32_32x32x16_bf16 v[16:31], v[80:83], a[0:3], v[16:31]
    v_mfma_f32_32x32x16_bf16 v[16:31], v[84:87], a[8:11], v[16:31]
    v_mfma_f32_32x32x16_bf16 v[16:31], v[88:91], a[16:19], v[16:31]
    v_mfma_f32_32x32x16_bf16 v[16:31], v[92:95], a[24:27], v[16:31]
    v_mfma_f32_32x32x16_bf16 v[32:47], v[80:83], a[32:35], 0
    v_mfma_f32_32x32x16_bf16 v[32:47], v[84:87], a[40:43], v[32:47]
    v_mfma_f32_32x32x16_bf16 v[32:47], v[88:91], a[48:51], v[32:47]
    v_mfma_f32_32x32x16_bf16 v[32:47], v[92:95], a[56:59], v[32:47]
    s_nop 7
    s_nop 7
    s_waitcnt lgkmcnt(2)
    v_mfma_f32_32x32x16_bf16 v[48:63], v[112:115], v[124:127], 0
    s_mov_b32 m0, s33
    s_lshl_b32 s80, s44, 3
    s_mov_b64 exec, 1
    ds_add_rtn_u32 v167, v1, v13 offset:4
    s_mov_b64 exec, -1
    v_exp_f32 v16, v16
    v_exp_f32 v17, v17
    v_exp_f32 v18, v18
    v_mfma_f32_32x32x16_bf16 v[48:63], v[128:131], a[68:71], v[48:63]
    v_exp_f32 v19, v19
    v_exp_f32 v20, v20
    v_exp_f32 v21, v21
    v_mfma_f32_32x32x16_bf16 v[48:63], v[80:83], a[4:7], v[48:63]
    v_exp_f32 v22, v22
    v_exp_f32 v23, v23
    v_exp_f32 v24, v24
    v_mfma_f32_32x32x16_bf16 v[48:63], v[84:87], a[12:15], v[48:63]
    v_exp_f32 v25, v25
    v_exp_f32 v26, v26
    v_exp_f32 v27, v27
    v_mfma_f32_32x32x16_bf16 v[48:63], v[88:91], a[20:23], v[48:63]
    v_exp_f32 v28, v28
    v_exp_f32 v29, v29
    v_exp_f32 v30, v30
    v_exp_f32 v31, v31
    v_add_u32 v148, s80, v166
    v_mad_u32_u16 v8, v150, s35, v140
    ds_read_b32 v153, v148 offset:2144
    v_mad_u32_u16 v9, v150, s35, v141 op_sel:[1,0,0,0]
    v_pk_add_f32 v[16:17], v[16:17], v[14:15]
    v_pk_add_f32 v[18:19], v[18:19], v[14:15]
    v_pk_add_f32 v[20:21], v[20:21], v[14:15]
    v_pk_add_f32 v[22:23], v[22:23], v[14:15]
    v_pk_add_f32 v[24:25], v[24:25], v[14:15]
    v_pk_add_f32 v[26:27], v[26:27], v[14:15]
    v_pk_add_f32 v[28:29], v[28:29], v[14:15]
    v_pk_add_f32 v[30:31], v[30:31], v[14:15]
    v_mfma_f32_32x32x16_bf16 v[48:63], v[92:95], a[28:31], v[48:63]
    v_rcp_f32 v16, v16
    v_rcp_f32 v17, v17
    v_rcp_f32 v18, v18
    v_mfma_f32_32x32x16_bf16 v[64:79], v[80:83], a[36:39], 0
    v_rcp_f32 v19, v19
    v_rcp_f32 v20, v20
    v_rcp_f32 v21, v21
    v_mfma_f32_32x32x16_bf16 v[64:79], v[84:87], a[44:47], v[64:79]
    v_rcp_f32 v22, v22
    v_rcp_f32 v23, v23
    v_rcp_f32 v24, v24
    v_mfma_f32_32x32x16_bf16 v[64:79], v[88:91], a[52:55], v[64:79]
    v_rcp_f32 v25, v25
    v_rcp_f32 v26, v26
    v_rcp_f32 v27, v27
    v_mfma_f32_32x32x16_bf16 v[64:79], v[92:95], a[60:63], v[64:79]
    v_rcp_f32 v28, v28
    v_rcp_f32 v29, v29
    v_rcp_f32 v30, v30
    v_rcp_f32 v31, v31
    v_mad_u32_u16 v10, v151, s35, v142
    v_mad_u32_u16 v11, v151, s35, v143 op_sel:[1,0,0,0]
    v_lshl_add_u32 v12, v152, 5, v144
    v_and_b32_sdwa v113, v152, v155 dst_sel:DWORD dst_unused:UNUSED_PAD src0_sel:WORD_1 src1_sel:DWORD
    v_mov_b32 v112, v116
    v_mov_b32 v114, 0
    s_waitcnt vmcnt(0) lgkmcnt(0)
    buffer_load_dwordx4 v8, s[12:15], 0 offen offset:0 lds
    v_pk_add_f32 v[4:5], v[16:17], v[18:19]
    ds_read_b128 v[96:99], v136 offset:32768
    v_pk_mul_f32 v[6:7], v[16:17], v[32:33]
    buffer_load_dwordx4 v9, s[12:15], 0 offen offset:1024 lds
    v_pk_fma_f32 v[6:7], v[18:19], v[34:35], v[6:7]
    ds_read_b128 v[100:103], v137 offset:32768
    v_pk_add_f32 v[4:5], v[20:21], v[4:5]
    buffer_load_dwordx4 v10, s[12:15], 0 offen offset:2048 lds
    v_pk_fma_f32 v[6:7], v[20:21], v[36:37], v[6:7]
    ds_read_b128 v[104:107], v138 offset:32768
    v_pk_add_f32 v[4:5], v[22:23], v[4:5]
    buffer_load_dwordx4 v11, s[12:15], 0 offen offset:3072 lds
    v_pk_fma_f32 v[6:7], v[22:23], v[38:39], v[6:7]
    ds_read_b128 v[108:111], v139 offset:32768
    buffer_load_dwordx4 v[128:131], v12, s[16:19], 0 offen
    v_add_f32 v8, v4, v5
    v_add_f32 v9, v6, v7
    v_cvt_f64_f32 v[10:11], v8
    v_cvt_f64_f32 v[8:9], v9
    ds_add_f64 v157, v[10:11] offset:256
    ds_add_f64 v157, v[8:9] offset:768
    v_pk_add_f32 v[4:5], v[24:25], v[26:27]
    v_pk_mul_f32 v[6:7], v[24:25], v[40:41]
    v_pk_fma_f32 v[6:7], v[26:27], v[42:43], v[6:7]
    v_pk_add_f32 v[4:5], v[28:29], v[4:5]
    v_pk_fma_f32 v[6:7], v[28:29], v[44:45], v[6:7]
    v_pk_add_f32 v[4:5], v[30:31], v[4:5]
    v_pk_fma_f32 v[6:7], v[30:31], v[46:47], v[6:7]
    v_add_u32_sdwa v154, v153, v145 dst_sel:DWORD dst_unused:UNUSED_PAD src0_sel:WORD_0 src1_sel:DWORD
    v_add_u32 v159, v154, v1
    v_readfirstlane_b32 s46, v167
    ds_read_b32 v120, v154 offset:0
    v_add_f32 v8, v4, v5
    v_add_f32 v9, v6, v7
    v_cvt_f64_f32 v[10:11], v8
    v_cvt_f64_f32 v[8:9], v9
    ds_add_f64 v158, v[10:11] offset:256
    ds_add_f64 v158, v[8:9] offset:768
    s_waitcnt lgkmcnt(2)
    v_mfma_f32_32x32x16_bf16 v[16:31], v[116:119], v[120:123], 0
    s_lshl_b32 s80, s46, 6
    s_lshl_b32 s81, s46, 7
    ds_read_b32 v124, v154 offset:128
    v_exp_f32 v48, v48
    v_exp_f32 v49, v49
    v_exp_f32 v50, v50
    v_mfma_f32_32x32x16_bf16 v[16:31], v[132:135], a[64:67], v[16:31]
    v_exp_f32 v51, v51
    v_exp_f32 v52, v52
    v_exp_f32 v53, v53
    v_mfma_f32_32x32x16_bf16 v[16:31], v[96:99], a[0:3], v[16:31]
    v_exp_f32 v54, v54
    v_exp_f32 v55, v55
    v_exp_f32 v56, v56
    v_mfma_f32_32x32x16_bf16 v[16:31], v[100:103], a[8:11], v[16:31]
    v_exp_f32 v57, v57
    v_exp_f32 v58, v58
    v_exp_f32 v59, v59
    v_mfma_f32_32x32x16_bf16 v[16:31], v[104:107], a[16:19], v[16:31]
    v_exp_f32 v60, v60
    v_exp_f32 v61, v61
    v_exp_f32 v62, v62
    v_exp_f32 v63, v63
    v_add_u32 v146, s80, v164
    v_add_u32 v147, s81, v165
    v_pk_add_f32 v[48:49], v[48:49], v[14:15]
    v_pk_add_f32 v[50:51], v[50:51], v[14:15]
    ds_read2_b32 v[150:151], v146 offset0:0 offset1:4
    v_pk_add_f32 v[52:53], v[52:53], v[14:15]
    v_pk_add_f32 v[54:55], v[54:55], v[14:15]
    ds_read_b32 v152, v147 offset:13248
    v_pk_add_f32 v[56:57], v[56:57], v[14:15]
    v_pk_add_f32 v[58:59], v[58:59], v[14:15]
    v_pk_add_f32 v[60:61], v[60:61], v[14:15]
    v_pk_add_f32 v[62:63], v[62:63], v[14:15]
    v_mfma_f32_32x32x16_bf16 v[16:31], v[108:111], a[24:27], v[16:31]
    v_rcp_f32 v48, v48
    v_rcp_f32 v49, v49
    v_rcp_f32 v50, v50
    v_mfma_f32_32x32x16_bf16 v[32:47], v[96:99], a[32:35], 0
    v_rcp_f32 v51, v51
    v_rcp_f32 v52, v52
    v_rcp_f32 v53, v53
    v_mfma_f32_32x32x16_bf16 v[32:47], v[100:103], a[40:43], v[32:47]
    v_rcp_f32 v54, v54
    v_rcp_f32 v55, v55
    v_rcp_f32 v56, v56
    v_mfma_f32_32x32x16_bf16 v[32:47], v[104:107], a[48:51], v[32:47]
    v_rcp_f32 v57, v57
    v_rcp_f32 v58, v58
    v_rcp_f32 v59, v59
    v_mfma_f32_32x32x16_bf16 v[32:47], v[108:111], a[56:59], v[32:47]
    v_rcp_f32 v60, v60
    v_rcp_f32 v61, v61
    v_rcp_f32 v62, v62
    v_rcp_f32 v63, v63
    s_nop 0
    v_pk_add_f32 v[4:5], v[48:49], v[50:51]
    v_pk_mul_f32 v[6:7], v[48:49], v[64:65]
    v_pk_fma_f32 v[6:7], v[50:51], v[66:67], v[6:7]
    v_pk_add_f32 v[4:5], v[52:53], v[4:5]
    v_pk_fma_f32 v[6:7], v[52:53], v[68:69], v[6:7]
    v_pk_add_f32 v[4:5], v[54:55], v[4:5]
    v_pk_fma_f32 v[6:7], v[54:55], v[70:71], v[6:7]
    v_add_f32 v8, v4, v5
    v_add_f32 v9, v6, v7
    v_cvt_f64_f32 v[10:11], v8
    v_cvt_f64_f32 v[8:9], v9
    ds_add_f64 v157, v[10:11] offset:512
    ds_add_f64 v157, v[8:9] offset:1024
    v_pk_add_f32 v[4:5], v[56:57], v[58:59]
    v_pk_mul_f32 v[6:7], v[56:57], v[72:73]
    v_pk_fma_f32 v[6:7], v[58:59], v[74:75], v[6:7]
    v_pk_add_f32 v[4:5], v[60:61], v[4:5]
    v_pk_fma_f32 v[6:7], v[60:61], v[76:77], v[6:7]
    v_pk_add_f32 v[4:5], v[62:63], v[4:5]
    v_pk_fma_f32 v[6:7], v[62:63], v[78:79], v[6:7]
    v_add_f32 v8, v4, v5
    v_add_f32 v9, v6, v7
    v_cvt_f64_f32 v[10:11], v8
    v_cvt_f64_f32 v[8:9], v9
    ds_add_f64 v158, v[10:11] offset:512
    ds_add_f64 v158, v[8:9] offset:1024
    s_cmp_lt_u32 s44, s31
    s_mov_b32 s44, s45
    s_mov_b32 s45, s46
    s_cbranch_scc0 K3_BATCHEND
    s_branch K3_LOOP1
    .p2align 3
K3_LOOP:
    s_waitcnt lgkmcnt(2)
    v_mfma_f32_32x32x16_bf16 v[48:63], v[112:115], v[124:127], 0
    s_mov_b32 m0, s33
    s_lshl_b32 s80, s44, 3
    s_mov_b64 exec, 1
    ds_add_rtn_u32 v167, v1, v13 offset:4
    s_mov_b64 exec, -1
    v_exp_f32 v16, v16
    v_exp_f32 v17, v17
    v_exp_f32 v18, v18
    v_mfma_f32_32x32x16_bf16 v[48:63], v[128:131], a[68:71], v[48:63]
    v_exp_f32 v19, v19
    v_exp_f32 v20, v20
    v_exp_f32 v21, v21
    v_mfma_f32_32x32x16_bf16 v[48:63], v[80:83], a[4:7], v[48:63]
    v_exp_f32 v22, v22
    v_exp_f32 v23, v23
    v_exp_f32 v24, v24
    v_mfma_f32_32x32x16_bf16 v[48:63], v[84:87], a[12:15], v[48:63]
    v_exp_f32 v25, v25
    v_exp_f32 v26, v26
    v_exp_f32 v27, v27
    v_mfma_f32_32x32x16_bf16 v[48:63], v[88:91], a[20:23], v[48:63]
    v_exp_f32 v28, v28
    v_exp_f32 v29, v29
    v_exp_f32 v30, v30
    v_exp_f32 v31, v31
    v_add_u32 v148, s80, v166
    v_mad_u32_u16 v8, v150, s35, v140
    ds_read_b32 v153, v148 offset:2144
    v_mad_u32_u16 v9, v150, s35, v141 op_sel:[1,0,0,0]
    v_pk_add_f32 v[16:17], v[16:17], v[14:15]
    v_pk_add_f32 v[18:19], v[18:19], v[14:15]
    v_pk_add_f32 v[20:21], v[20:21], v[14:15]
    v_pk_add_f32 v[22:23], v[22:23], v[14:15]
    v_pk_add_f32 v[24:25], v[24:25], v[14:15]
    v_pk_add_f32 v[26:27], v[26:27], v[14:15]
    v_pk_add_f32 v[28:29], v[28:29], v[14:15]
    v_pk_add_f32 v[30:31], v[30:31], v[14:15]
    v_mfma_f32_32x32x16_bf16 v[48:63], v[92:95], a[28:31], v[48:63]
    v_rcp_f32 v16, v16
    v_rcp_f32 v17, v17
    v_rcp_f32 v18, v18
    v_mfma_f32_32x32x16_bf16 v[64:79], v[80:83], a[36:39], 0
    v_rcp_f32 v19, v19
    v_rcp_f32 v20, v20
    v_rcp_f32 v21, v21
    v_mfma_f32_32x32x16_bf16 v[64:79], v[84:87], a[44:47], v[64:79]
    v_rcp_f32 v22, v22
    v_rcp_f32 v23, v23
    v_rcp_f32 v24, v24
    v_mfma_f32_32x32x16_bf16 v[64:79], v[88:91], a[52:55], v[64:79]
    v_rcp_f32 v25, v25
    v_rcp_f32 v26, v26
    v_rcp_f32 v27, v27
    v_mfma_f32_32x32x16_bf16 v[64:79], v[92:95], a[60:63], v[64:79]
    v_rcp_f32 v28, v28
    v_rcp_f32 v29, v29
    v_rcp_f32 v30, v30
    v_rcp_f32 v31, v31
    v_mad_u32_u16 v10, v151, s35, v142
    v_mad_u32_u16 v11, v151, s35, v143 op_sel:[1,0,0,0]
    v_lshl_add_u32 v12, v152, 5, v144
    v_and_b32_sdwa v113, v152, v155 dst_sel:DWORD dst_unused:UNUSED_PAD src0_sel:WORD_1 src1_sel:DWORD
    s_waitcnt vmcnt(0) lgkmcnt(0)
    buffer_load_dwordx4 v8, s[12:15], 0 offen offset:0 lds
    v_pk_add_f32 v[4:5], v[16:17], v[18:19]
    ds_read_b128 v[96:99], v136 offset:32768
    v_pk_mul_f32 v[6:7], v[16:17], v[32:33]
    buffer_load_dwordx4 v9, s[12:15], 0 offen offset:1024 lds
    v_pk_fma_f32 v[6:7], v[18:19], v[34:35], v[6:7]
    ds_read_b128 v[100:103], v137 offset:32768
    v_pk_add_f32 v[4:5], v[20:21], v[4:5]
    buffer_load_dwordx4 v10, s[12:15], 0 offen offset:2048 lds
    v_pk_fma_f32 v[6:7], v[20:21], v[36:37], v[6:7]
    ds_read_b128 v[104:107], v138 offset:32768
    v_pk_add_f32 v[4:5], v[22:23], v[4:5]
    buffer_load_dwordx4 v11, s[12:15], 0 offen offset:3072 lds
    v_pk_fma_f32 v[6:7], v[22:23], v[38:39], v[6:7]
    ds_read_b128 v[108:111], v139 offset:32768
    v_pk_add_f32 v[4:5], v[24:25], v[4:5]
    buffer_load_dwordx4 v[128:131], v12, s[16:19], 0 offen
    v_pk_fma_f32 v[6:7], v[24:25], v[40:41], v[6:7]
    v_pk_add_f32 v[4:5], v[26:27], v[4:5]
    v_pk_fma_f32 v[6:7], v[26:27], v[42:43], v[6:7]
    v_pk_add_f32 v[4:5], v[28:29], v[4:5]
    v_pk_fma_f32 v[6:7], v[28:29], v[44:45], v[6:7]
    v_pk_add_f32 v[4:5], v[30:31], v[4:5]
    v_pk_fma_f32 v[6:7], v[30:31], v[46:47], v[6:7]
    v_add_u32_sdwa v154, v153, v145 dst_sel:DWORD dst_unused:UNUSED_PAD src0_sel:WORD_0 src1_sel:DWORD
    v_add_u32 v159, v154, v1
    v_readfirstlane_b32 s46, v167
    ds_read_b32 v120, v154 offset:0
    v_add_f32 v8, v4, v5
    v_add_f32 v9, v6, v7
    v_cvt_f64_f32 v[10:11], v8
    v_cvt_f64_f32 v[8:9], v9
    ds_add_f64 v157, v[10:11] offset:256
    ds_add_f64 v157, v[8:9] offset:768
    s_waitcnt lgkmcnt(2)
    v_mfma_f32_32x32x16_bf16 v[16:31], v[116:119], v[120:123], 0
    s_lshl_b32 s80, s46, 6
    s_lshl_b32 s81, s46, 7
    ds_read_b32 v124, v154 offset:128
    v_exp_f32 v48, v48
    v_exp_f32 v49, v49
    v_exp_f32 v50, v50
    v_mfma_f32_32x32x16_bf16 v[16:31], v[132:135], a[64:67], v[16:31]
    v_exp_f32 v51, v51
    v_exp_f32 v52, v52
    v_exp_f32 v53, v53
    v_mfma_f32_32x32x16_bf16 v[16:31], v[96:99], a[0:3], v[16:31]
    v_exp_f32 v54, v54
    v_exp_f32 v55, v55
    v_exp_f32 v56, v56
    v_mfma_f32_32x32x16_bf16 v[16:31], v[100:103], a[8:11], v[16:31]
    v_exp_f32 v57, v57
    v_exp_f32 v58, v58
    v_exp_f32 v59, v59
    v_mfma_f32_32x32x16_bf16 v[16:31], v[104:107], a[16:19], v[16:31]
    v_exp_f32 v60, v60
    v_exp_f32 v61, v61
    v_exp_f32 v62, v62
    v_exp_f32 v63, v63
    v_add_u32 v146, s80, v164
    v_add_u32 v147, s81, v165
    v_pk_add_f32 v[48:49], v[48:49], v[14:15]
    v_pk_add_f32 v[50:51], v[50:51], v[14:15]
    ds_read2_b32 v[150:151], v146 offset0:0 offset1:4
    v_pk_add_f32 v[52:53], v[52:53], v[14:15]
    v_pk_add_f32 v[54:55], v[54:55], v[14:15]
    ds_read_b32 v152, v147 offset:13248
    v_pk_add_f32 v[56:57], v[56:57], v[14:15]
    v_pk_add_f32 v[58:59], v[58:59], v[14:15]
    v_pk_add_f32 v[60:61], v[60:61], v[14:15]
    v_pk_add_f32 v[62:63], v[62:63], v[14:15]
    v_mfma_f32_32x32x16_bf16 v[16:31], v[108:111], a[24:27], v[16:31]
    v_rcp_f32 v48, v48
    v_rcp_f32 v49, v49
    v_rcp_f32 v50, v50
    v_mfma_f32_32x32x16_bf16 v[32:47], v[96:99], a[32:35], 0
    v_rcp_f32 v51, v51
    v_rcp_f32 v52, v52
    v_rcp_f32 v53, v53
    v_mfma_f32_32x32x16_bf16 v[32:47], v[100:103], a[40:43], v[32:47]
    v_rcp_f32 v54, v54
    v_rcp_f32 v55, v55
    v_rcp_f32 v56, v56
    v_mfma_f32_32x32x16_bf16 v[32:47], v[104:107], a[48:51], v[32:47]
    v_rcp_f32 v57, v57
    v_rcp_f32 v58, v58
    v_rcp_f32 v59, v59
    v_mfma_f32_32x32x16_bf16 v[32:47], v[108:111], a[56:59], v[32:47]
    v_rcp_f32 v60, v60
    v_rcp_f32 v61, v61
    v_rcp_f32 v62, v62
    v_rcp_f32 v63, v63
    s_nop 0
    v_pk_add_f32 v[4:5], v[48:49], v[50:51]
    v_pk_mul_f32 v[6:7], v[48:49], v[64:65]
    v_pk_fma_f32 v[6:7], v[50:51], v[66:67], v[6:7]
    v_pk_add_f32 v[4:5], v[52:53], v[4:5]
    v_pk_fma_f32 v[6:7], v[52:53], v[68:69], v[6:7]
    v_pk_add_f32 v[4:5], v[54:55], v[4:5]
    v_pk_fma_f32 v[6:7], v[54:55], v[70:71], v[6:7]
    v_pk_add_f32 v[4:5], v[56:57], v[4:5]
    v_pk_fma_f32 v[6:7], v[56:57], v[72:73], v[6:7]
    v_pk_add_f32 v[4:5], v[58:59], v[4:5]
    v_pk_fma_f32 v[6:7], v[58:59], v[74:75], v[6:7]
    v_pk_add_f32 v[4:5], v[60:61], v[4:5]
    v_pk_fma_f32 v[6:7], v[60:61], v[76:77], v[6:7]
    v_pk_add_f32 v[4:5], v[62:63], v[4:5]
    v_pk_fma_f32 v[6:7], v[62:63], v[78:79], v[6:7]
    v_add_f32 v8, v4, v5
    v_add_f32 v9, v6, v7
    v_cvt_f64_f32 v[10:11], v8
    v_cvt_f64_f32 v[8:9], v9
    ds_add_f64 v157, v[10:11] offset:512
    ds_add_f64 v157, v[8:9] offset:1024
    s_cmp_lt_u32 s44, s31
    s_mov_b32 s44, s45
    s_mov_b32 s45, s46
    s_cbranch_scc0 K3_BATCHEND
K3_LOOP1:
    s_waitcnt lgkmcnt(2)
    v_mfma_f32_32x32x16_bf16 v[48:63], v[116:119], v[124:127], 0
    s_mov_b32 m0, s34
    s_lshl_b32 s80, s44, 3
    s_mov_b64 exec, 1
    ds_add_rtn_u32 v167, v1, v13 offset:4
    s_mov_b64 exec, -1
    v_exp_f32 v16, v16
    v_exp_f32 v17, v17
    v_exp_f32 v18, v18
    v_mfma_f32_32x32x16_bf16 v[48:63], v[132:135], a[68:71], v[48:63]
    v_exp_f32 v19, v19
    v_exp_f32 v20, v20
    v_exp_f32 v21, v21
    v_mfma_f32_32x32x16_bf16 v[48:63], v[96:99], a[4:7], v[48:63]
    v_exp_f32 v22, v22
    v_exp_f32 v23, v23
    v_exp_f32 v24, v24
    v_mfma_f32_32x32x16_bf16 v[48:63], v[100:103], a[12:15], v[48:63]
    v_exp_f32 v25, v25
    v_exp_f32 v26, v26
    v_exp_f32 v27, v27
    v_mfma_f32_32x32x16_bf16 v[48:63], v[104:107], a[20:23], v[48:63]
    v_exp_f32 v28, v28
    v_exp_f32 v29, v29
    v_exp_f32 v30, v30
    v_exp_f32 v31, v31
    v_add_u32 v148, s80, v166
    v_mad_u32_u16 v8, v150, s35, v140
    ds_read_b32 v153, v148 offset:2144
    v_mad_u32_u16 v9, v150, s35, v141 op_sel:[1,0,0,0]
    v_pk_add_f32 v[16:17], v[16:17], v[14:15]
    v_pk_add_f32 v[18:19], v[18:19], v[14:15]
    v_pk_add_f32 v[20:21], v[20:21], v[14:15]
    v_pk_add_f32 v[22:23], v[22:23], v[14:15]
    v_pk_add_f32 v[24:25], v[24:25], v[14:15]
    v_pk_add_f32 v[26:27], v[26:27], v[14:15]
    v_pk_add_f32 v[28:29], v[28:29], v[14:15]
    v_pk_add_f32 v[30:31], v[30:31], v[14:15]
    v_mfma_f32_32x32x16_bf16 v[48:63], v[108:111], a[28:31], v[48:63]
    v_rcp_f32 v16, v16
    v_rcp_f32 v17, v17
    v_rcp_f32 v18, v18
    v_mfma_f32_32x32x16_bf16 v[64:79], v[96:99], a[36:39], 0
    v_rcp_f32 v19, v19
    v_rcp_f32 v20, v20
    v_rcp_f32 v21, v21
    v_mfma_f32_32x32x16_bf16 v[64:79], v[100:103], a[44:47], v[64:79]
    v_rcp_f32 v22, v22
    v_rcp_f32 v23, v23
    v_rcp_f32 v24, v24
    v_mfma_f32_32x32x16_bf16 v[64:79], v[104:107], a[52:55], v[64:79]
    v_rcp_f32 v25, v25
    v_rcp_f32 v26, v26
    v_rcp_f32 v27, v27
    v_mfma_f32_32x32x16_bf16 v[64:79], v[108:111], a[60:63], v[64:79]
    v_rcp_f32 v28, v28
    v_rcp_f32 v29, v29
    v_rcp_f32 v30, v30
    v_rcp_f32 v31, v31
    v_mad_u32_u16 v10, v151, s35, v142
    v_mad_u32_u16 v11, v151, s35, v143 op_sel:[1,0,0,0]
    v_lshl_add_u32 v12, v152, 5, v144
    v_and_b32_sdwa v117, v152, v155 dst_sel:DWORD dst_unused:UNUSED_PAD src0_sel:WORD_1 src1_sel:DWORD
    s_waitcnt vmcnt(0) lgkmcnt(0)
    buffer_load_dwordx4 v8, s[12:15], 0 offen offset:0 lds
    v_pk_add_f32 v[4:5], v[16:17], v[18:19]
    ds_read_b128 v[80:83], v136 offset:0
    v_pk_mul_f32 v[6:7], v[16:17], v[32:33]
    buffer_load_dwordx4 v9, s[12:15], 0 offen offset:1024 lds
    v_pk_fma_f32 v[6:7], v[18:19], v[34:35], v[6:7]
    ds_read_b128 v[84:87], v137 offset:0
    v_pk_add_f32 v[4:5], v[20:21], v[4:5]
    buffer_load_dwordx4 v10, s[12:15], 0 offen offset:2048 lds
    v_pk_fma_f32 v[6:7], v[20:21], v[36:37], v[6:7]
    ds_read_b128 v[88:91], v138 offset:0
    v_pk_add_f32 v[4:5], v[22:23], v[4:5]
    buffer_load_dwordx4 v11, s[12:15], 0 offen offset:3072 lds
    v_pk_fma_f32 v[6:7], v[22:23], v[38:39], v[6:7]
    ds_read_b128 v[92:95], v139 offset:0
    v_pk_add_f32 v[4:5], v[24:25], v[4:5]
    buffer_load_dwordx4 v[132:135], v12, s[16:19], 0 offen
    v_pk_fma_f32 v[6:7], v[24:25], v[40:41], v[6:7]
    v_pk_add_f32 v[4:5], v[26:27], v[4:5]
    v_pk_fma_f32 v[6:7], v[26:27], v[42:43], v[6:7]
    v_pk_add_f32 v[4:5], v[28:29], v[4:5]
    v_pk_fma_f32 v[6:7], v[28:29], v[44:45], v[6:7]
    v_pk_add_f32 v[4:5], v[30:31], v[4:5]
    v_pk_fma_f32 v[6:7], v[30:31], v[46:47], v[6:7]
    v_add_u32_sdwa v154, v153, v145 dst_sel:DWORD dst_unused:UNUSED_PAD src0_sel:WORD_0 src1_sel:DWORD
    v_add_u32 v157, v154, v1
    v_readfirstlane_b32 s46, v167
    ds_read_b32 v120, v154 offset:0
    v_add_f32 v8, v4, v5
    v_add_f32 v9, v6, v7
    v_cvt_f64_f32 v[10:11], v8
    v_cvt_f64_f32 v[8:9], v9
    ds_add_f64 v159, v[10:11] offset:256
    ds_add_f64 v159, v[8:9] offset:768
    s_waitcnt lgkmcnt(2)
    v_mfma_f32_32x32x16_bf16 v[16:31], v[112:115], v[120:123], 0
    s_lshl_b32 s80, s46, 6
    s_lshl_b32 s81, s46, 7
    ds_read_b32 v124, v154 offset:128
    v_exp_f32 v48, v48
    v_exp_f32 v49, v49
    v_exp_f32 v50, v50
    v_mfma_f32_32x32x16_bf16 v[16:31], v[128:131], a[64:67], v[16:31]
    v_exp_f32 v51, v51
    v_exp_f32 v52, v52
    v_exp_f32 v53, v53
    v_mfma_f32_32x32x16_bf16 v[16:31], v[80:83], a[0:3], v[16:31]
    v_exp_f32 v54, v54
    v_exp_f32 v55, v55
    v_exp_f32 v56, v56
    v_mfma_f32_32x32x16_bf16 v[16:31], v[84:87], a[8:11], v[16:31]
    v_exp_f32 v57, v57
    v_exp_f32 v58, v58
    v_exp_f32 v59, v59
    v_mfma_f32_32x32x16_bf16 v[16:31], v[88:91], a[16:19], v[16:31]
    v_exp_f32 v60, v60
    v_exp_f32 v61, v61
    v_exp_f32 v62, v62
    v_exp_f32 v63, v63
    v_add_u32 v146, s80, v164
    v_add_u32 v147, s81, v165
    v_pk_add_f32 v[48:49], v[48:49], v[14:15]
    v_pk_add_f32 v[50:51], v[50:51], v[14:15]
    ds_read2_b32 v[150:151], v146 offset0:0 offset1:4
    v_pk_add_f32 v[52:53], v[52:53], v[14:15]
    v_pk_add_f32 v[54:55], v[54:55], v[14:15]
    ds_read_b32 v152, v147 offset:13248
    v_pk_add_f32 v[56:57], v[56:57], v[14:15]
    v_pk_add_f32 v[58:59], v[58:59], v[14:15]
    v_pk_add_f32 v[60:61], v[60:61], v[14:15]
    v_pk_add_f32 v[62:63], v[62:63], v[14:15]
    v_mfma_f32_32x32x16_bf16 v[16:31], v[92:95], a[24:27], v[16:31]
    v_rcp_f32 v48, v48
    v_rcp_f32 v49, v49
    v_rcp_f32 v50, v50
    v_mfma_f32_32x32x16_bf16 v[32:47], v[80:83], a[32:35], 0
    v_rcp_f32 v51, v51
    v_rcp_f32 v52, v52
    v_rcp_f32 v53, v53
    v_mfma_f32_32x32x16_bf16 v[32:47], v[84:87], a[40:43], v[32:47]
    v_rcp_f32 v54, v54
    v_rcp_f32 v55, v55
    v_rcp_f32 v56, v56
    v_mfma_f32_32x32x16_bf16 v[32:47], v[88:91], a[48:51], v[32:47]
    v_rcp_f32 v57, v57
    v_rcp_f32 v58, v58
    v_rcp_f32 v59, v59
    v_mfma_f32_32x32x16_bf16 v[32:47], v[92:95], a[56:59], v[32:47]
    v_rcp_f32 v60, v60
    v_rcp_f32 v61, v61
    v_rcp_f32 v62, v62
    v_rcp_f32 v63, v63
    s_nop 0
    v_pk_add_f32 v[4:5], v[48:49], v[50:51]
    v_pk_mul_f32 v[6:7], v[48:49], v[64:65]
    v_pk_fma_f32 v[6:7], v[50:51], v[66:67], v[6:7]
    v_pk_add_f32 v[4:5], v[52:53], v[4:5]
    v_pk_fma_f32 v[6:7], v[52:53], v[68:69], v[6:7]
    v_pk_add_f32 v[4:5], v[54:55], v[4:5]
    v_pk_fma_f32 v[6:7], v[54:55], v[70:71], v[6:7]
    v_pk_add_f32 v[4:5], v[56:57], v[4:5]
    v_pk_fma_f32 v[6:7], v[56:57], v[72:73], v[6:7]
    v_pk_add_f32 v[4:5], v[58:59], v[4:5]
    v_pk_fma_f32 v[6:7], v[58:59], v[74:75], v[6:7]
    v_pk_add_f32 v[4:5], v[60:61], v[4:5]
    v_pk_fma_f32 v[6:7], v[60:61], v[76:77], v[6:7]
    v_pk_add_f32 v[4:5], v[62:63], v[4:5]
    v_pk_fma_f32 v[6:7], v[62:63], v[78:79], v[6:7]
    v_add_f32 v8, v4, v5
    v_add_f32 v9, v6, v7
    v_cvt_f64_f32 v[10:11], v8
    v_cvt_f64_f32 v[8:9], v9
    ds_add_f64 v159, v[10:11] offset:512
    ds_add_f64 v159, v[8:9] offset:1024
    s_cmp_lt_u32 s44, s31
    s_mov_b32 s44, s45
    s_mov_b32 s45, s46
    s_cbranch_scc1 K3_LOOP
K3_BATCHEND:
    s_waitcnt vmcnt(0) lgkmcnt(0)
    s_and_b32 s37, s28, 1
    s_cmp_eq_u32 s37, 0
    s_cbranch_scc1 K3_NOU
    v_bfe_u32 v9, v0, 5, 1
    v_lshlrev_b32 v9, 9, v9
    v_add_u32 v9, v9, v1
    v_add_u32 v9, s33, v9
    ds_write_b32 v9, a72 offset:0
    ds_write_b32 v9, a73 offset:128
    ds_write_b32 v9, a74 offset:256
    ds_write_b32 v9, a75 offset:384
    ds_write_b32 v9, a76 offset:1024
    ds_write_b32 v9, a77 offset:1152
    ds_write_b32 v9, a78 offset:1280
    ds_write_b32 v9, a79 offset:1408
    ds_write_b32 v9, a80 offset:2048
    ds_write_b32 v9, a81 offset:2176
    ds_write_b32 v9, a82 offset:2304
    ds_write_b32 v9, a83 offset:2432
    ds_write_b32 v9, a84 offset:3072
    ds_write_b32 v9, a85 offset:3200
    ds_write_b32 v9, a86 offset:3328
    ds_write_b32 v9, a87 offset:3456
K3_NOU:
    v_cmp_gt_u32 vcc, 0x188, v0
    v_lshrrev_b32 v16, 3, v0
    v_and_b32 v17, 7, v0
    v_mul_u32_u24 v10, 1280, v16
    v_lshl_add_u32 v10, v17, 6, v10
    v_add_u32 v10, 34240, v10
    v_lshrrev_b32 v11, 5, v16
    v_lshrrev_b32 v12, 2, v17
    v_lshlrev_b32 v11, 13, v11
    v_lshl_add_u32 v11, v12, 14, v11
    v_and_b32 v12, 31, v16
    v_lshl_add_u32 v11, v12, 7, v11
    v_and_b32 v12, 3, v17
    v_lshl_add_u32 v11, v12, 5, v11
    v_add_u32 v11, 101120, v11
    s_waitcnt lgkmcnt(0)
    s_barrier
    s_cmp_eq_u32 s32, 1
    s_cbranch_scc1 K3_HALF2
    s_cmp_eq_u32 s47, 0
    s_cbranch_scc1 K3_EPI
    v_mov_b32 v8, 0
    ds_read_b32 v9, v8
    s_waitcnt lgkmcnt(0)
    v_readfirstlane_b32 s80, v9
    s_nop 3
    s_cmp_eq_u32 s80, 0
    s_cbranch_scc1 K3_EPI
    s_lshl_b32 s81, s80, 2
    s_add_u32 s81, s81, 12
    v_mov_b32 v8, s81
    ds_read_b32 v9, v8
    s_waitcnt lgkmcnt(0)
    v_readfirstlane_b32 s82, v9
    s_barrier
    s_sub_u32 s80, s80, 1
    v_mov_b32 v8, 0
    v_mov_b32 v9, s80
    ds_write_b32 v8, v9
    s_lshr_b32 s83, s82, 24
    s_bfe_u32 s84, s82, 0xc000c
    s_and_b32 s85, s82, 0xfff
    s_mul_i32 s86, s83, 12500
    s_add_u32 s86, s86, 8388608
    s_lshl_b32 s84, s84, 2
    s_add_u32 s86, s86, s84
    s_lshl_b32 s85, s85, 2
    s_add_u32 s42, s86, s85
    s_mul_i32 s83, s83, 3125
    v_mov_b32 v3, s83
    s_mov_b32 s30, 0
    s_mov_b32 s32, 3
    v_lshlrev_b32 v8, 4, v0
    v_add_u32 v8, s86, v8
    buffer_load_dwordx4 v[16:19], v8, s[40:43], 0 offen
    v_add_u32 v8, 8192, v8
    buffer_load_dwordx4 v[20:23], v8, s[40:43], 0 offen
    v_add_u32 v8, 8192, v8
    buffer_load_dwordx4 v[24:27], v8, s[40:43], 0 offen
    v_add_u32 v8, 8192, v8
    buffer_load_dwordx4 v[28:31], v8, s[40:43], 0 offen
    v_and_b32 v13, 63, v0
    s_waitcnt vmcnt(0)
    s_branch K3_BATCH
K3_INLINE:
    s_cmp_lg_u32 s32, 0
    s_cbranch_scc1 K3_INLINEDONE
    v_and_b32 v9, 63, v25
    v_cmp_eq_u32 vcc, 63, v9
    s_cbranch_vccz K3_IN_14
    s_ff1_i32_b64 s80, vcc
    s_nop 3
    v_readlane_b32 s81, v25, s80
    s_lshr_b32 s82, s81, 18
    s_cmp_gt_u32 s82, 64
    s_cbranch_scc1 K3_IN_14
    s_lshr_b32 s83, s80, 3
    s_lshl_b32 s84, s28, 3
    s_add_u32 s83, s83, s84
    s_add_u32 s83, s83, 0
    s_mul_i32 s8, s83, 3125
    s_bfe_u32 s84, s81, 0xc0006
    s_add_u32 s84, s84, s8
    s_lshl_b32 s84, s84, 2
    s_add_u32 s84, s84, 8388608
    s_lshl_b32 s82, s82, 2
    s_add_u32 s42, s84, s82
    v_lshlrev_b32 v9, 2, v13
    v_add_u32 v9, s84, v9
    buffer_load_dword v96, v9, s[40:43], 0 offen
    s_mov_b32 m0, s80
    v_mov_b32 v9, 0
    s_nop 0
    v_writelane_b32 v25, 0, m0
    s_waitcnt vmcnt(0)
    s_mov_b32 s42, 8388608
    s_branch K3_INLINEDONE
K3_IN_14:
    v_and_b32 v9, 63, v27
    v_cmp_eq_u32 vcc, 63, v9
    s_cbranch_vccz K3_IN_15
    s_ff1_i32_b64 s80, vcc
    s_nop 3
    v_readlane_b32 s81, v27, s80
    s_lshr_b32 s82, s81, 18
    s_cmp_gt_u32 s82, 64
    s_cbranch_scc1 K3_IN_15
    s_lshr_b32 s83, s80, 3
    s_lshl_b32 s84, s28, 3
    s_add_u32 s83, s83, s84
    s_add_u32 s83, s83, 64
    s_mul_i32 s8, s83, 3125
    s_bfe_u32 s84, s81, 0xc0006
    s_add_u32 s84, s84, s8
    s_lshl_b32 s84, s84, 2
    s_add_u32 s84, s84, 8388608
    s_lshl_b32 s82, s82, 2
    s_add_u32 s42, s84, s82
    v_lshlrev_b32 v9, 2, v13
    v_add_u32 v9, s84, v9
    buffer_load_dword v96, v9, s[40:43], 0 offen
    s_mov_b32 m0, s80
    v_mov_b32 v9, 0
    s_nop 0
    v_writelane_b32 v27, 0, m0
    s_waitcnt vmcnt(0)
    s_mov_b32 s42, 8388608
    s_branch K3_INLINEDONE
K3_IN_15:
    v_and_b32 v9, 63, v29
    v_cmp_eq_u32 vcc, 63, v9
    s_cbranch_vccz K3_IN_16
    s_ff1_i32_b64 s80, vcc
    s_nop 3
    v_readlane_b32 s81, v29, s80
    s_lshr_b32 s82, s81, 18
    s_cmp_gt_u32 s82, 64
    s_cbranch_scc1 K3_IN_16
    s_lshr_b32 s83, s80, 3
    s_lshl_b32 s84, s28, 3
    s_add_u32 s83, s83, s84
    s_add_u32 s83, s83, 128
    s_mul_i32 s8, s83, 3125
    s_bfe_u32 s84, s81, 0xc0006
    s_add_u32 s84, s84, s8
    s_lshl_b32 s84, s84, 2
    s_add_u32 s84, s84, 8388608
    s_lshl_b32 s82, s82, 2
    s_add_u32 s42, s84, s82
    v_lshlrev_b32 v9, 2, v13
    v_add_u32 v9, s84, v9
    buffer_load_dword v96, v9, s[40:43], 0 offen
    s_mov_b32 m0, s80
    v_mov_b32 v9, 0
    s_nop 0
    v_writelane_b32 v29, 0, m0
    s_waitcnt vmcnt(0)
    s_mov_b32 s42, 8388608
    s_branch K3_INLINEDONE
K3_IN_16:
    v_and_b32 v9, 63, v31
    v_cmp_eq_u32 vcc, 63, v9
    s_cbranch_vccz K3_IN_17
    s_ff1_i32_b64 s80, vcc
    s_nop 3
    v_readlane_b32 s81, v31, s80
    s_lshr_b32 s82, s81, 18
    s_cmp_gt_u32 s82, 64
    s_cbranch_scc1 K3_IN_17
    s_lshr_b32 s83, s80, 3
    s_lshl_b32 s84, s28, 3
    s_add_u32 s83, s83, s84
    s_add_u32 s83, s83, 192
    s_mul_i32 s8, s83, 3125
    s_bfe_u32 s84, s81, 0xc0006
    s_add_u32 s84, s84, s8
    s_lshl_b32 s84, s84, 2
    s_add_u32 s84, s84, 8388608
    s_lshl_b32 s82, s82, 2
    s_add_u32 s42, s84, s82
    v_lshlrev_b32 v9, 2, v13
    v_add_u32 v9, s84, v9
    buffer_load_dword v96, v9, s[40:43], 0 offen
    s_mov_b32 m0, s80
    v_mov_b32 v9, 0
    s_nop 0
    v_writelane_b32 v31, 0, m0
    s_waitcnt vmcnt(0)
    s_mov_b32 s42, 8388608
    s_branch K3_INLINEDONE
K3_IN_17:
    s_branch K3_INLINEDONE
K3_MIXCAP:
    v_cmp_gt_u32 vcc, 32, v11
    s_and_b64 s[20:21], vcc, s[20:21]
    s_mov_b32 s9, 32
    s_branch K3_MIXCAPDONE
K3_CLAMP:
    v_lshrrev_b32 v9, 4, v48
    v_subrev_u32 v9, 8, v9
    v_max_i32 v9, 0, v9
    v_lshlrev_b32 v9, 2, v9
    v_sub_u32 v32, v32, v9
    v_lshrrev_b32 v9, 4, v49
    v_subrev_u32 v9, 8, v9
    v_max_i32 v9, 0, v9
    v_lshlrev_b32 v9, 2, v9
    v_sub_u32 v33, v33, v9
    v_lshrrev_b32 v9, 4, v50
    v_subrev_u32 v9, 8, v9
    v_max_i32 v9, 0, v9
    v_lshlrev_b32 v9, 2, v9
    v_sub_u32 v34, v34, v9
    v_lshrrev_b32 v9, 4, v51
    v_subrev_u32 v9, 8, v9
    v_max_i32 v9, 0, v9
    v_lshlrev_b32 v9, 2, v9
    v_sub_u32 v35, v35, v9
    v_lshrrev_b32 v9, 4, v52
    v_subrev_u32 v9, 8, v9
    v_max_i32 v9, 0, v9
    v_lshlrev_b32 v9, 2, v9
    v_sub_u32 v36, v36, v9
    v_lshrrev_b32 v9, 4, v53
    v_subrev_u32 v9, 8, v9
    v_max_i32 v9, 0, v9
    v_lshlrev_b32 v9, 2, v9
    v_sub_u32 v37, v37, v9
    v_lshrrev_b32 v9, 4, v54
    v_subrev_u32 v9, 8, v9
    v_max_i32 v9, 0, v9
    v_lshlrev_b32 v9, 2, v9
    v_sub_u32 v38, v38, v9
    v_lshrrev_b32 v9, 4, v55
    v_subrev_u32 v9, 8, v9
    v_max_i32 v9, 0, v9
    v_lshlrev_b32 v9, 2, v9
    v_sub_u32 v39, v39, v9
    v_lshrrev_b32 v9, 4, v56
    v_min_u32 v9, 8, v9
    v_lshl_add_u32 v40, v9, 2, v40
    v_lshrrev_b32 v24, 18, v24
    v_lshrrev_b32 v9, 4, v57
    v_min_u32 v9, 8, v9
    v_lshl_add_u32 v41, v9, 2, v41
    v_lshrrev_b32 v25, 18, v25
    v_lshrrev_b32 v9, 4, v58
    v_min_u32 v9, 8, v9
    v_lshl_add_u32 v42, v9, 2, v42
    v_lshrrev_b32 v26, 18, v26
    v_lshrrev_b32 v9, 4, v59
    v_min_u32 v9, 8, v9
    v_lshl_add_u32 v43, v9, 2, v43
    v_lshrrev_b32 v27, 18, v27
    v_lshrrev_b32 v9, 4, v60
    v_min_u32 v9, 8, v9
    v_lshl_add_u32 v44, v9, 2, v44
    v_lshrrev_b32 v28, 18, v28
    v_lshrrev_b32 v9, 4, v61
    v_min_u32 v9, 8, v9
    v_lshl_add_u32 v45, v9, 2, v45
    v_lshrrev_b32 v29, 18, v29
    v_lshrrev_b32 v9, 4, v62
    v_min_u32 v9, 8, v9
    v_lshl_add_u32 v46, v9, 2, v46
    v_lshrrev_b32 v30, 18, v30
    v_lshrrev_b32 v9, 4, v63
    v_min_u32 v9, 8, v9
    v_lshl_add_u32 v47, v9, 2, v47
    v_lshrrev_b32 v31, 18, v31
    s_branch K3_CLAMPDONE
K3_BATCH:
    v_mov_b32 v4, -1
    s_lshl_b32 s80, s28, 8
    s_add_u32 m0, s80, 3392
    s_nop 0
    ds_write_addtid_b32 v4 offset:0
    ds_write_addtid_b32 v4 offset:2048
    ds_write_addtid_b32 v4 offset:4096
    ds_write_addtid_b32 v4 offset:6144
    ds_write_addtid_b32 v4 offset:8192
    ds_write_addtid_b32 v4 offset:10240
    ds_write_addtid_b32 v4 offset:12288
    ds_write_addtid_b32 v4 offset:14336
    ds_write_addtid_b32 v4 offset:16384
    ds_write_addtid_b32 v4 offset:18432
    ds_write_addtid_b32 v4 offset:20480
    ds_write_addtid_b32 v4 offset:22528
    ds_write_addtid_b32 v4 offset:24576
    ds_write_addtid_b32 v4 offset:26624
    s_cmp_gt_u32 s28, 3
    s_cbranch_scc1 K3_PF_18
    s_cmp_eq_u32 s28, 3
    s_cselect_b32 exec_hi, 0, -1
    ds_write_addtid_b32 v4 offset:28672
    s_mov_b32 exec_hi, -1
K3_PF_18:
    v_lshlrev_b32 v8, 4, v0
    v_mov_b32 v4, 0
    v_mov_b32 v5, 0
    v_mov_b32 v6, 0
    v_mov_b32 v7, 0
    v_cmp_gt_u32 vcc, 82, v0
    s_and_saveexec_b64 s[38:39], vcc
    ds_write_b128 v8, v[4:7] offset:2080
    s_mov_b64 exec, s[38:39]
    v_add_u32 v9, 97024, v8
    v_cmp_gt_u32 vcc, 176, v0
    s_and_saveexec_b64 s[38:39], vcc
    ds_write_b128 v9, v[4:7]
    s_mov_b64 exec, s[38:39]
    v_mov_b32 v9, 4
    v_mov_b32 v10, 16
    ds_write_b32 v9, v10
    s_waitcnt lgkmcnt(0)
    s_barrier
    s_branch K3_HIST
K3_SPLIT:
    s_waitcnt vmcnt(0) lgkmcnt(0)
    s_barrier
    s_bfe_u32 s38, s28, 0x10001
    s_lshl_b32 s80, s38, 12
    s_add_u32 s80, s80, 101120
    s_sub_u32 s80, s80, s33
    v_add_u32 v12, s80, v136
    ds_read_b128 v[80:83], v12
    v_add_u32 v12, s80, v137
    ds_read_b128 v[84:87], v12
    v_add_u32 v12, s80, v138
    ds_read_b128 v[88:91], v12
    v_add_u32 v12, s80, v139
    ds_read_b128 v[92:95], v12
    s_and_b32 s37, s28, 1
    s_lshr_b32 s39, s28, 2
    s_lshl_b32 s80, s37, 13
    s_lshl_b32 s81, s39, 10
    s_add_u32 s80, s80, s81
    s_add_u32 s80, s80, 109312
    v_lshlrev_b32 v12, 4, v13
    v_add_u32 v12, s80, v12
    ds_read_b128 v[96:99], v12 offset:0
    ds_read_b128 v[100:103], v12 offset:2048
    ds_read_b128 v[104:107], v12 offset:4096
    ds_read_b128 v[108:111], v12 offset:6144
    s_waitcnt lgkmcnt(0)
    v_mfma_f32_32x32x16_bf16 a[72:87], v[80:83], v[96:99], 0
    v_mfma_f32_32x32x16_bf16 a[72:87], v[84:87], v[100:103], a[72:87]
    v_mfma_f32_32x32x16_bf16 a[72:87], v[88:91], v[104:107], a[72:87]
    v_mfma_f32_32x32x16_bf16 a[72:87], v[92:95], v[108:111], a[72:87]
    v_and_b32 v9, 63, v0
    v_lshlrev_b32 v9, 4, v9
    v_add_u32 v9, 129792, v9
    ds_read_b128 a[0:3], v9 offset:0
    ds_read_b128 a[4:7], v9 offset:1024
    ds_read_b128 a[8:11], v9 offset:2048
    ds_read_b128 a[12:15], v9 offset:3072
    ds_read_b128 a[16:19], v9 offset:4096
    ds_read_b128 a[20:23], v9 offset:5120
    ds_read_b128 a[24:27], v9 offset:6144
    ds_read_b128 a[28:31], v9 offset:7168
    ds_read_b128 a[32:35], v9 offset:8192
    ds_read_b128 a[36:39], v9 offset:9216
    ds_read_b128 a[40:43], v9 offset:10240
    ds_read_b128 a[44:47], v9 offset:11264
    ds_read_b128 a[48:51], v9 offset:12288
    ds_read_b128 a[52:55], v9 offset:13312
    ds_read_b128 a[56:59], v9 offset:14336
    ds_read_b128 a[60:63], v9 offset:15360
    ds_read_b128 a[64:67], v9 offset:16384
    ds_read_b128 a[68:71], v9 offset:17408
    s_and_b32 s37, s28, 1
    s_cmp_eq_u32 s37, 1
    s_cbranch_scc1 K3_SPLIT2
    s_bfe_u32 s38, s28, 0x10001
    s_lshr_b32 s39, s28, 2
    s_mul_i32 s80, s38, 40960
    s_lshl_b32 s81, s39, 7
    s_add_u32 s80, s80, s81
    s_add_u32 s80, s80, 1280
    v_bfe_u32 v9, v0, 5, 1
    v_mul_u32_u24 v9, 5120, v9
    v_add_u32 v10, v9, v145
    v_add_u32 v10, s80, v10
    s_nop 7
    s_mov_b32 s81, 0xbfb8aa3b
    v_accvgpr_read_b32 v64, a72
    v_accvgpr_read_b32 v65, a73
    v_accvgpr_read_b32 v66, a74
    v_accvgpr_read_b32 v67, a75
    v_accvgpr_read_b32 v68, a76
    v_accvgpr_read_b32 v69, a77
    v_accvgpr_read_b32 v70, a78
    v_accvgpr_read_b32 v71, a79
    v_accvgpr_read_b32 v72, a80
    v_accvgpr_read_b32 v73, a81
    v_accvgpr_read_b32 v74, a82
    v_accvgpr_read_b32 v75, a83
    v_accvgpr_read_b32 v76, a84
    v_accvgpr_read_b32 v77, a85
    v_accvgpr_read_b32 v78, a86
    v_accvgpr_read_b32 v79, a87
    v_mul_f32 v64, s81, v64
    v_mul_f32 v65, s81, v65
    v_mul_f32 v66, s81, v66
    v_mul_f32 v67, s81, v67
    v_mul_f32 v68, s81, v68
    v_mul_f32 v69, s81, v69
    v_mul_f32 v70, s81, v70
    v_mul_f32 v71, s81, v71
    v_mul_f32 v72, s81, v72
    v_mul_f32 v73, s81, v73
    v_mul_f32 v74, s81, v74
    v_mul_f32 v75, s81, v75
    v_mul_f32 v76, s81, v76
    v_mul_f32 v77, s81, v77
    v_mul_f32 v78, s81, v78
    v_mul_f32 v79, s81, v79
    v_cvt_pk_bf16_f32 v32, v64, v64
    v_cvt_pk_bf16_f32 v33, v65, v65
    v_cvt_pk_bf16_f32 v34, v66, v66
    v_cvt_pk_bf16_f32 v35, v67, v67
    v_cvt_pk_bf16_f32 v36, v68, v68
    v_cvt_pk_bf16_f32 v37, v69, v69
    v_cvt_pk_bf16_f32 v38, v70, v70
    v_cvt_pk_bf16_f32 v39, v71, v71
    v_cvt_pk_bf16_f32 v40, v72, v72
    v_cvt_pk_bf16_f32 v41, v73, v73
    v_cvt_pk_bf16_f32 v42, v74, v74
    v_cvt_pk_bf16_f32 v43, v75, v75
    v_cvt_pk_bf16_f32 v44, v76, v76
    v_cvt_pk_bf16_f32 v45, v77, v77
    v_cvt_pk_bf16_f32 v46, v78, v78
    v_cvt_pk_bf16_f32 v47, v79, v79
    v_lshlrev_b32 v32, 16, v32
    v_lshlrev_b32 v33, 16, v33
    v_lshlrev_b32 v34, 16, v34
    v_lshlrev_b32 v35, 16, v35
    v_lshlrev_b32 v36, 16, v36
    v_lshlrev_b32 v37, 16, v37
    v_lshlrev_b32 v38, 16, v38
    v_lshlrev_b32 v39, 16, v39
    v_lshlrev_b32 v40, 16, v40
    v_lshlrev_b32 v41, 16, v41
    v_lshlrev_b32 v42, 16, v42
    v_lshlrev_b32 v43, 16, v43
    v_lshlrev_b32 v44, 16, v44
    v_lshlrev_b32 v45, 16, v45
    v_lshlrev_b32 v46, 16, v46
    v_lshlrev_b32 v47, 16, v47
    v_sub_f32 v32, v64, v32
    v_sub_f32 v33, v65, v33
    v_sub_f32 v34, v66, v34
    v_sub_f32 v35, v67, v35
    v_sub_f32 v36, v68, v36
    v_sub_f32 v37, v69, v37
    v_sub_f32 v38, v70, v38
    v_sub_f32 v39, v71, v39
    v_sub_f32 v40, v72, v40
    v_sub_f32 v41, v73, v41
    v_sub_f32 v42, v74, v42
    v_sub_f32 v43, v75, v43
    v_sub_f32 v44, v76, v44
    v_sub_f32 v45, v77, v45
    v_sub_f32 v46, v78, v46
    v_sub_f32 v47, v79, v47
    v_cvt_pk_bf16_f32 v64, v64, v32
    v_cvt_pk_bf16_f32 v65, v65, v33
    v_cvt_pk_bf16_f32 v66, v66, v34
    v_cvt_pk_bf16_f32 v67, v67, v35
    v_cvt_pk_bf16_f32 v68, v68, v36
    v_cvt_pk_bf16_f32 v69, v69, v37
    v_cvt_pk_bf16_f32 v70, v70, v38
    v_cvt_pk_bf16_f32 v71, v71, v39
    v_cvt_pk_bf16_f32 v72, v72, v40
    v_cvt_pk_bf16_f32 v73, v73, v41
    v_cvt_pk_bf16_f32 v74, v74, v42
    v_cvt_pk_bf16_f32 v75, v75, v43
    v_cvt_pk_bf16_f32 v76, v76, v44
    v_cvt_pk_bf16_f32 v77, v77, v45
    v_cvt_pk_bf16_f32 v78, v78, v46
    v_cvt_pk_bf16_f32 v79, v79, v47
    ds_write_b32 v10, v64 offset:0
    ds_write_b32 v10, v65 offset:1280
    ds_write_b32 v10, v66 offset:2560
    ds_write_b32 v10, v67 offset:3840
    ds_write_b32 v10, v68 offset:10240
    ds_write_b32 v10, v69 offset:11520
    ds_write_b32 v10, v70 offset:12800
    ds_write_b32 v10, v71 offset:14080
    s_cmp_eq_u32 s38, 1
    s_cbranch_scc1 K3_NW_19
    ds_write_b32 v10, v72 offset:20480
    ds_write_b32 v10, v73 offset:21760
    ds_write_b32 v10, v74 offset:23040
    ds_write_b32 v10, v75 offset:24320
    ds_write_b32 v10, v76 offset:30720
    ds_write_b32 v10, v77 offset:32000
    ds_write_b32 v10, v78 offset:33280
    ds_write_b32 v10, v79 offset:34560
    s_branch K3_NWE_20
K3_NW_19:
    s_mov_b32 exec_hi, 0
    ds_write_b32 v10, v72 offset:20480
    s_mov_b32 exec_hi, -1
K3_NWE_20:
K3_SPLIT2:
    s_waitcnt lgkmcnt(0)
    s_barrier
    s_mov_b32 s32, 1
    v_lshrrev_b32 v8, 3, v0
    v_and_b32 v9, 7, v0
    v_lshlrev_b32 v9, 3, v9
    s_lshl_b32 s37, s2, 14
    v_add_u32 v9, s37, v9
    v_add_u32 v10, s2, v8

    v_add_u32 v11, 0, v10
    v_and_b32 v11, 255, v11
    v_lshl_add_u32 v164, v11, 6, v9
    v_add_u32 v11, 64, v10
    v_and_b32 v11, 255, v11
    v_lshl_add_u32 v165, v11, 6, v9
    v_add_u32 v11, 128, v10
    v_and_b32 v11, 255, v11
    v_lshl_add_u32 v166, v11, 6, v9
    v_add_u32 v11, 192, v10
    v_and_b32 v11, 255, v11
    v_lshl_add_u32 v167, v11, 6, v9
    s_movk_i32 s37, 3125
    v_mul_u32_u24 v3, s37, v8
    buffer_load_dwordx2 v[16:17], v164, s[40:43], 0 offen
    buffer_load_dwordx2 v[18:19], v165, s[40:43], 0 offen
    v_mov_b32 v20, 0
    v_mov_b32 v21, 0
    v_mov_b32 v22, 0
    v_mov_b32 v23, 0
    s_waitcnt vmcnt(0)
    s_branch K3_BATCH
K3_HALF2:
    s_mov_b32 s32, 2
    v_lshrrev_b32 v8, 3, v0
    v_and_b32 v9, 7, v0
    v_lshlrev_b32 v9, 3, v9
    s_lshl_b32 s37, s2, 14
    v_add_u32 v9, s37, v9
    v_add_u32 v10, s2, v8

    v_add_u32 v11, 0, v10
    v_and_b32 v11, 255, v11
    v_lshl_add_u32 v164, v11, 6, v9
    v_add_u32 v11, 64, v10
    v_and_b32 v11, 255, v11
    v_lshl_add_u32 v165, v11, 6, v9
    v_add_u32 v11, 128, v10
    v_and_b32 v11, 255, v11
    v_lshl_add_u32 v166, v11, 6, v9
    v_add_u32 v11, 192, v10
    v_and_b32 v11, 255, v11
    v_lshl_add_u32 v167, v11, 6, v9
    s_movk_i32 s37, 3125
    v_mul_u32_u24 v3, s37, v8
    v_mov_b32 v16, 0
    v_mov_b32 v17, 0
    v_mov_b32 v18, 0
    v_mov_b32 v19, 0
    buffer_load_dwordx2 v[20:21], v166, s[40:43], 0 offen
    buffer_load_dwordx2 v[22:23], v167, s[40:43], 0 offen
    v_and_b32 v13, 63, v0
    s_waitcnt vmcnt(0) lgkmcnt(0)
    s_branch K3_BATCH
K3_MARKERS:
    s_mov_b32 s47, 1
    v_lshrrev_b32 v84, 3, v0
    v_mov_b32 v85, 1
    v_mov_b32 v86, 0
    s_mov_b32 s80, 99796
    v_cmp_eq_u32 vcc, s80, v41
    s_and_b64 vcc, vcc, s[66:67]
    s_cbranch_vccz K3_MK_21
    s_andn2_b64 s[66:67], s[66:67], vcc
    s_mov_b64 exec, vcc
    ds_add_rtn_u32 v88, v86, v85
    v_add_u32 v87, 0, v84
    v_lshlrev_b32 v87, 24, v87
    v_bfe_u32 v89, v25, 6, 12
    v_lshl_add_u32 v87, v89, 12, v87
    v_lshrrev_b32 v89, 18, v25
    v_add_u32 v87, v89, v87
    s_waitcnt lgkmcnt(0)
    v_lshlrev_b32 v88, 2, v88
    ds_write_b32 v88, v87 offset:16
    s_mov_b64 exec, -1
K3_MK_21:
    v_cmp_eq_u32 vcc, s80, v43
    s_and_b64 vcc, vcc, s[70:71]
    s_cbranch_vccz K3_MK_22
    s_andn2_b64 s[70:71], s[70:71], vcc
    s_mov_b64 exec, vcc
    ds_add_rtn_u32 v88, v86, v85
    v_add_u32 v87, 64, v84
    v_lshlrev_b32 v87, 24, v87
    v_bfe_u32 v89, v27, 6, 12
    v_lshl_add_u32 v87, v89, 12, v87
    v_lshrrev_b32 v89, 18, v27
    v_add_u32 v87, v89, v87
    s_waitcnt lgkmcnt(0)
    v_lshlrev_b32 v88, 2, v88
    ds_write_b32 v88, v87 offset:16
    s_mov_b64 exec, -1
K3_MK_22:
    v_cmp_eq_u32 vcc, s80, v45
    s_and_b64 vcc, vcc, s[74:75]
    s_cbranch_vccz K3_MK_23
    s_andn2_b64 s[74:75], s[74:75], vcc
    s_mov_b64 exec, vcc
    ds_add_rtn_u32 v88, v86, v85
    v_add_u32 v87, 128, v84
    v_lshlrev_b32 v87, 24, v87
    v_bfe_u32 v89, v29, 6, 12
    v_lshl_add_u32 v87, v89, 12, v87
    v_lshrrev_b32 v89, 18, v29
    v_add_u32 v87, v89, v87
    s_waitcnt lgkmcnt(0)
    v_lshlrev_b32 v88, 2, v88
    ds_write_b32 v88, v87 offset:16
    s_mov_b64 exec, -1
K3_MK_23:
    v_cmp_eq_u32 vcc, s80, v47
    s_and_b64 vcc, vcc, s[78:79]
    s_cbranch_vccz K3_MK_24
    s_andn2_b64 s[78:79], s[78:79], vcc
    s_mov_b64 exec, vcc
    ds_add_rtn_u32 v88, v86, v85
    v_add_u32 v87, 192, v84
    v_lshlrev_b32 v87, 24, v87
    v_bfe_u32 v89, v31, 6, 12
    v_lshl_add_u32 v87, v89, 12, v87
    v_lshrrev_b32 v89, 18, v31
    v_add_u32 v87, v89, v87
    s_waitcnt lgkmcnt(0)
    v_lshlrev_b32 v88, 2, v88
    ds_write_b32 v88, v87 offset:16
    s_mov_b64 exec, -1
K3_MK_24:
    s_branch K3_MARKDONE
K3_TAIL:
    v_subrev_u32 v134, 8, v129
    v_max_i32 v134, 0, v134
    v_mov_b32 v135, v134
    s_nop 1
    v_add_u32_dpp v135, v135, v135 row_shr:1 row_mask:0xf bank_mask:0xf bound_ctrl:0
    s_nop 1
    v_add_u32_dpp v135, v135, v135 row_shr:2 row_mask:0xf bank_mask:0xf bound_ctrl:0
    s_nop 1
    v_add_u32_dpp v135, v135, v135 row_shr:4 row_mask:0xf bank_mask:0xf bound_ctrl:0
    s_nop 1
    v_add_u32_dpp v135, v135, v135 row_shr:8 row_mask:0xf bank_mask:0xf bound_ctrl:0
    s_nop 1
    v_add_u32_dpp v135, v135, v135 row_bcast:15 row_mask:0xa bank_mask:0xf
    s_nop 1
    v_add_u32_dpp v135, v135, v135 row_bcast:31 row_mask:0xc bank_mask:0xf
    s_nop 1
    v_readlane_b32 s80, v135, 63
    v_sub_u32 v135, v135, v134
    v_add_u32 v135, s81, v135
    v_subrev_u32 v149, 8, v135
    v_lshlrev_b32 v149, 6, v149
    ds_write_b32 v9, v149 offset:32
    s_add_u32 s81, s81, s80
    s_mov_b32 s36, 1
    s_branch K3_TAILDONE
K3_TAILDESC:
    s_mov_b32 s36, 8
K3_TLOOP:
    v_cmp_lt_u32 vcc, s36, v129
    s_cbranch_vccz K3_TAILDESCDONE
    s_lshl_b32 s80, s36, 4
    v_subrev_u32 v84, s80, v128
    v_min_u32 v84, 16, v84
    v_lshl_add_u32 v84, v84, 22, v130
    s_sub_u32 s80, s36, 8
    v_add_u32 v85, s80, v135
    v_lshlrev_b32 v85, 2, v85
    s_mov_b64 exec, vcc
    ds_write_b32 v85, v84 offset:2144
    v_cmp_gt_u32 vcc, 64, v85
    s_and_b64 exec, exec, vcc
    ds_write_b32 v85, v84 offset:2080
    s_mov_b64 exec, -1
    s_add_u32 s36, s36, 1
    s_branch K3_TLOOP
K3_EPI:
    s_and_saveexec_b64 s[38:39], vcc
    s_cbranch_execz K3_END
    ds_read_b128 v[24:27], v11
    ds_read_b128 v[28:31], v11 offset:16
    ds_read_b128 v[48:51], v10 offset:256
    ds_read_b128 v[64:67], v10 offset:768
    ds_read_b128 v[52:55], v10 offset:272
    ds_read_b128 v[68:71], v10 offset:784
    ds_read_b128 v[56:59], v10 offset:288
    ds_read_b128 v[72:75], v10 offset:800
    ds_read_b128 v[60:63], v10 offset:304
    ds_read_b128 v[76:79], v10 offset:816
    v_add_u32 v8, s29, v16
    v_lshlrev_b32 v8, 7, v8
    v_lshl_add_u32 v8, v17, 4, v8
    s_mov_b32 s80, 0x358637bd
    s_waitcnt lgkmcnt(0)
    v_cvt_f32_f64 v32, v[48:49]
    v_cvt_f32_f64 v33, v[50:51]
    v_cvt_f32_f64 v34, v[52:53]
    v_cvt_f32_f64 v35, v[54:55]
    v_cvt_f32_f64 v36, v[56:57]
    v_cvt_f32_f64 v37, v[58:59]
    v_cvt_f32_f64 v38, v[60:61]
    v_cvt_f32_f64 v39, v[62:63]
    v_cvt_f32_f64 v40, v[64:65]
    v_cvt_f32_f64 v41, v[66:67]
    v_cvt_f32_f64 v42, v[68:69]
    v_cvt_f32_f64 v43, v[70:71]
    v_cvt_f32_f64 v44, v[72:73]
    v_cvt_f32_f64 v45, v[74:75]
    v_cvt_f32_f64 v46, v[76:77]
    v_cvt_f32_f64 v47, v[78:79]
    v_add_f32 v32, s80, v32
    v_add_f32 v33, s80, v33
    v_add_f32 v34, s80, v34
    v_add_f32 v35, s80, v35
    v_add_f32 v36, s80, v36
    v_add_f32 v37, s80, v37
    v_add_f32 v38, s80, v38
    v_add_f32 v39, s80, v39
    v_rcp_f32 v32, v32
    v_rcp_f32 v33, v33
    v_rcp_f32 v34, v34
    v_rcp_f32 v35, v35
    v_rcp_f32 v36, v36
    v_rcp_f32 v37, v37
    v_rcp_f32 v38, v38
    v_rcp_f32 v39, v39
    s_nop 0
    v_fma_f32 v24, v40, v32, v24
    v_fma_f32 v25, v41, v33, v25
    v_fma_f32 v26, v42, v34, v26
    v_fma_f32 v27, v43, v35, v27
    v_fma_f32 v28, v44, v36, v28
    v_fma_f32 v29, v45, v37, v29
    v_fma_f32 v30, v46, v38, v30
    v_fma_f32 v31, v47, v39, v31
    v_max_f32 v24, 0, v24
    v_max_f32 v25, 0, v25
    v_max_f32 v26, 0, v26
    v_max_f32 v27, 0, v27
    v_max_f32 v28, 0, v28
    v_max_f32 v29, 0, v29
    v_max_f32 v30, 0, v30
    v_max_f32 v31, 0, v31
    v_lshlrev_b32 v40, 16, v160
    v_and_b32 v41, 0xffff0000, v160
    v_add_f32 v24, v40, v24
    v_add_f32 v25, v41, v25
    v_lshlrev_b32 v40, 16, v161
    v_and_b32 v41, 0xffff0000, v161
    v_add_f32 v26, v40, v26
    v_add_f32 v27, v41, v27
    v_lshlrev_b32 v40, 16, v162
    v_and_b32 v41, 0xffff0000, v162
    v_add_f32 v28, v40, v28
    v_add_f32 v29, v41, v29
    v_lshlrev_b32 v40, 16, v163
    v_and_b32 v41, 0xffff0000, v163
    v_add_f32 v30, v40, v30
    v_add_f32 v31, v41, v31
    v_cvt_pk_bf16_f32 v44, v24, v25
    v_cvt_pk_bf16_f32 v45, v26, v27
    v_cvt_pk_bf16_f32 v46, v28, v29
    v_cvt_pk_bf16_f32 v47, v30, v31
    buffer_store_dwordx4 v[44:47], v8, s[24:27], 0 offen
K3_END:
    s_endpgm
.section .rodata,"a"
.p2align 6
.amdhsa_kernel bucket_kernel
  .amdhsa_next_free_vgpr 64
  .amdhsa_next_free_sgpr 64
  .amdhsa_accum_offset 64
  .amdhsa_group_segment_fixed_size 0
  .amdhsa_kernarg_size 96
  .amdhsa_user_sgpr_count 2
  .amdhsa_user_sgpr_kernarg_segment_ptr 1
  .amdhsa_system_sgpr_workgroup_id_x 1
  .amdhsa_float_denorm_mode_32 3
.end_amdhsa_kernel
.p2align 6
.amdhsa_kernel standalone__edge_featured_mpnn_gatedgcn__graph_kernel
  .amdhsa_next_free_vgpr 256
  .amdhsa_next_free_sgpr 102
  .amdhsa_accum_offset 168
  .amdhsa_group_segment_fixed_size 0
  .amdhsa_kernarg_size 96
  .amdhsa_user_sgpr_count 2
  .amdhsa_user_sgpr_kernarg_segment_ptr 1
  .amdhsa_system_sgpr_workgroup_id_x 1
  .amdhsa_float_denorm_mode_32 3
.end_amdhsa_kernel
```
